```python
import torch

def _softmax(x, axis=-1):
    return torch.softmax(x, dim=axis)
def _gelu(x):
    return torch.nn.functional.gelu(x, approximate="tanh")
def _silu(x):
    return torch.nn.functional.silu(x)
def _sigmoid(x):
    return torch.sigmoid(x)
def _layernorm(x, axis=-1, eps=1e-5):
    m = x.mean(dim=axis, keepdim=True)
    v = x.var(dim=axis, keepdim=True, unbiased=False)
    return (x - m) / torch.sqrt(v + eps)
def _scatter_add(tgt, idx, src, axis=0):
    return tgt.clone().index_add_(axis, idx, src)
def _segment_sum(src, seg, n):
    out = torch.zeros((n,) + src.shape[1:], dtype=src.dtype)
    return out.index_add_(0, seg, src)
def _pad(x, pw):
    flat = tuple(v for pair in reversed(pw) for v in pair)
    return torch.nn.functional.pad(x, flat)

kernel_name = 'concat_heads__softmax_full_mha__ssm_conv_s5__prompt'

def setup_inputs():

    _w = (lambda a: (lambda t: t.to(torch.bfloat16) if t.is_floating_point() else t)(torch.as_tensor(a)))
    def _A_setup():
        B, S, D = 1, 2048, 576
        return {
            "x": _w((lambda *s: torch.randn(*s, dtype=torch.bfloat16) * 0.2)(B, S, D)),
            "wqkv": _w((lambda *s: torch.randn(*s, dtype=torch.bfloat16) * 0.2)(D, 3 * D)),
            "wo": _w((lambda *s: torch.randn(*s, dtype=torch.bfloat16) * 0.05)(D, D)),
        }
    _A_in = _A_setup()

    def _B_setup():
        B, S, D = 1, 2048, 576
        P = D
        Lambda_re = -0.5 * (lambda _x: torch.exp(torch.as_tensor(_x)))((lambda *s: torch.randn(*s, dtype=torch.bfloat16) * 0.8)(P))
        Lambda_im = (lambda *s: torch.randn(*s, dtype=torch.bfloat16) * 0.8)(P) * 1.0
        B_re = (lambda *s: torch.randn(*s, dtype=torch.bfloat16) * 0.8)(P, D) * (D ** -0.5)
        B_im = (lambda *s: torch.randn(*s, dtype=torch.bfloat16) * 0.8)(P, D) * (D ** -0.5)
        C_re = (lambda *s: torch.randn(*s, dtype=torch.bfloat16) * 0.8)(D, P) * (P ** -0.5)
        C_im = (lambda *s: torch.randn(*s, dtype=torch.bfloat16) * 0.8)(D, P) * (P ** -0.5)
        log_dt = (lambda *s: torch.randn(*s, dtype=torch.bfloat16) * 0.8)(P) * 0.3 - 2.0
        Dskip = (lambda *s: torch.randn(*s, dtype=torch.bfloat16) * 0.8)(D)
        return {
            "x": _w((lambda *s: torch.randn(*s, dtype=torch.bfloat16) * 0.05)(B, S, D)),
            "Lambda_re": _w(Lambda_re),
            "Lambda_im": _w(Lambda_im),
            "B_re": _w(B_re),
            "B_im": _w(B_im),
            "C_re": _w(C_re),
            "C_im": _w(C_im),
            "log_dt": _w(log_dt),
            "Dskip": _w(Dskip),
        }
    _B_in = _B_setup()

    return {
        "A_x": _A_in["x"],
        "A_wqkv": _A_in["wqkv"],
        "A_wo": _A_in["wo"],
        "B_x": _B_in["x"],
        "B_Lambda_re": _B_in["Lambda_re"],
        "B_Lambda_im": _B_in["Lambda_im"],
        "B_B_re": _B_in["B_re"],
        "B_B_im": _B_in["B_im"],
        "B_C_re": _B_in["C_re"],
        "B_C_im": _B_in["C_im"],
        "B_log_dt": _B_in["log_dt"],
        "B_Dskip": _B_in["Dskip"],
    }

def reference(A_x, A_wqkv, A_wo, B_x, B_Lambda_re, B_Lambda_im, B_B_re, B_B_im, B_C_re, B_C_im, B_log_dt, B_Dskip):
    def _A_ref(x, wqkv, wo):
        B, S, D = x.shape
        H = 32; Dh = D // H
        qkv = (lambda x, *d: x.permute(*d))((x @ wqkv).reshape(B, S, 3, H, Dh), 2, 0, 3, 1, 4)
        q, k, v = qkv[0], qkv[1], qkv[2]
        scale = Dh ** -0.5
        scores = torch.einsum("bhqd,bhkd->bhqk", q, k) * scale
        p = _softmax(scores, axis=-1)
        o = torch.einsum("bhqk,bhkd->bhqd", p, v)
        return (lambda x, *d: x.permute(*d))(o, 0, 2, 1, 3).reshape(B, S, D) @ wo

    def _B_ref(x, Lambda_re, Lambda_im, B_re, B_im, C_re, C_im, log_dt, Dskip):
        Bsz, L, H = x.shape
        Lam = Lambda_re + 1j * Lambda_im
        Bmat = B_re + 1j * B_im
        Cmat = C_re + 1j * C_im
        dt = torch.exp(log_dt)
        Lam_bar = torch.exp(dt * Lam)
        B_bar = ((Lam_bar - 1.0) / Lam)[:, None] * Bmat
        Bu = torch.einsum("bld,pd->blp", x + 0j, B_bar)
        h = torch.zeros_like(Bu[:, 0, :])
        hs = []
        for t in range(L):
            h = Lam_bar[None, :] * h + Bu[:, t, :]
            hs.append(h)
        hseq = torch.stack(hs, 1)
        y = 2.0 * torch.einsum("blp,dp->bld", hseq, Cmat).real + x * Dskip[None, None, :]
        return y

    a = _A_ref(A_x, A_wqkv, A_wo)
    b = _B_ref(B_x, B_Lambda_re, B_Lambda_im, B_B_re, B_B_im, B_C_re, B_C_im, B_log_dt, B_Dskip)
    return torch.concatenate([a, b], axis=-1)
```

```asm
; @launch grid=(256,1,1) block=(512,1,1) lds=163840
.amdgcn_target "amdgcn-amd-amdhsa--gfx950"
.text
.globl concat_heads__softmax_full_mha__ssm_conv_s5__prompt_kernel
.p2align 8
.type concat_heads__softmax_full_mha__ssm_conv_s5__prompt_kernel,@function
concat_heads__softmax_full_mha__ssm_conv_s5__prompt_kernel:
    s_load_dwordx16 s[4:19], s[0:1], 0
    s_load_dwordx8 s[20:27], s[0:1], 64
    s_load_dwordx4 s[28:31], s[0:1], 96
    s_load_dwordx2 s[32:33], s[0:1], 112
    v_lshrrev_b32 v1, 6, v0
    s_cmp_ge_u32 s2, 256
    v_readfirstlane_b32 s3, v1
    s_cbranch_scc1 L_exit
    s_and_b32 s34, s2, 7
    s_lshr_b32 s35, s2, 3
    s_and_b32 s58, s34, 3
    s_lshl_b32 s58, s58, 2
    s_and_b32 s59, s35, 3
    s_add_u32 s58, s58, s59
    s_lshr_b32 s60, s34, 2
    s_lshr_b32 s61, s35, 2
    s_mul_i32 s59, s60, 7
    s_add_u32 s59, s59, s61
    s_mul_i32 s96, s60, 6
    s_add_u32 s96, s96, s61
    s_sub_u32 s96, s96, 2
    s_cmp_lt_u32 s61, 7
    s_cselect_b32 s97, 1, 0
    s_cmp_ge_u32 s61, 2
    s_cselect_b32 s60, 2, 0
    s_or_b32 s97, s97, s60
    s_and_b32 s63, s35, 3
    s_lshl_b32 s63, s63, 1
    s_add_u32 s63, s63, s61
    v_and_b32 v1, 63, v0
    s_cmp_ge_u32 s3, 4
    s_cbranch_scc0 L_comp
    s_sub_u32 s69, s3, 4
    s_lshl_b32 s56, s69, 12
    s_add_u32 s57, s56, 16384
    s_lshl_b32 s60, s58, 2
    s_add_u32 s60, s60, s69
    s_mul_i32 s66, s60, 36864
    s_add_u32 s63, s63, s34
    s_mul_i32 s61, s63, 57
    s_lshr_b32 s61, s61, 9
    s_mul_i32 s61, s61, 9
    s_sub_u32 s63, s63, s61
    s_mul_i32 s61, s69, 55296
    s_lshl_b32 s62, s59, 8
    s_add_u32 s61, s61, s62
    s_bitcmp1_b32 s97, 0
    s_cselect_b32 s60, s66, 1073741824
    s_cselect_b32 s61, s61, 1073741824
    s_mov_b32 s62, 221184
    v_lshrrev_b32 v30, 3, v1
    v_mul_u32_u24 v30, 1152, v30
    v_lshrrev_b32 v31, 4, v1
    v_and_b32 v29, 7, v1
    v_xor_b32 v31, v31, v29
    v_lshl_add_u32 v10, v31, 4, v30
    v_xor_b32 v31, 64, v10
    v_add_u32 v11, 8192, v31
    v_add_u32 v12, 16384, v10
    v_add_u32 v13, 24576, v31
    v_lshrrev_b32 v30, 4, v1
    v_lshlrev_b32 v31, 2, v30
    v_and_b32 v29, 15, v1
    v_xor_b32 v31, v31, v29
    v_mul_u32_u24 v30, 3456, v30
    v_lshl_add_u32 v14, v31, 4, v30
    v_add_u32 v15, 12800, v14
    v_add_u32 v16, 25600, v14
    v_add_u32 v17, 38400, v14
    s_mov_b32 s42, 2359296
    s_mov_b32 s43, 0x00020000
    s_mov_b32 s46, 1990656
    s_mov_b32 s47, 0x00020000
    s_waitcnt lgkmcnt(0)
    s_mov_b64 s[40:41], s[4:5]
    s_mov_b64 s[44:45], s[6:7]
    s_mov_b32 s7, 7
    s_lshl_b32 s48, s63, s7
    s_add_u32 s48, s48, s60
    s_mul_i32 s49, s63, s62
    s_add_u32 s49, s49, s61
    s_add_u32 s63, s63, 1
    s_cmp_eq_u32 s63, 9
    s_cselect_b32 s63, 0, s63
    s_add_u32 m0, s56, 65536
    s_nop 0
    buffer_load_dwordx4 v10, s[40:43], s48 offen offset:0 lds
    buffer_load_dwordx4 v11, s[40:43], s48 offen offset:1024 lds
    buffer_load_dwordx4 v12, s[40:43], s48 offen offset:2048 lds
    buffer_load_dwordx4 v13, s[40:43], s48 offen offset:3072 lds
    s_add_u32 m0, s57, 65536
    s_nop 0
    buffer_load_dwordx4 v14, s[44:47], s49 offen offset:0 lds
    buffer_load_dwordx4 v15, s[44:47], s49 offen offset:1024 lds
    buffer_load_dwordx4 v16, s[44:47], s49 offen offset:2048 lds
    buffer_load_dwordx4 v17, s[44:47], s49 offen offset:3072 lds
    s_lshl_b32 s48, s63, s7
    s_add_u32 s48, s48, s60
    s_mul_i32 s49, s63, s62
    s_add_u32 s49, s49, s61
    s_add_u32 s63, s63, 1
    s_cmp_eq_u32 s63, 9
    s_cselect_b32 s63, 0, s63
    s_add_u32 m0, s56, 98304
    s_nop 0
    buffer_load_dwordx4 v10, s[40:43], s48 offen offset:0 lds
    buffer_load_dwordx4 v11, s[40:43], s48 offen offset:1024 lds
    buffer_load_dwordx4 v12, s[40:43], s48 offen offset:2048 lds
    buffer_load_dwordx4 v13, s[40:43], s48 offen offset:3072 lds
    s_add_u32 m0, s57, 98304
    s_nop 0
    buffer_load_dwordx4 v14, s[44:47], s49 offen offset:0 lds
    buffer_load_dwordx4 v15, s[44:47], s49 offen offset:1024 lds
    buffer_load_dwordx4 v16, s[44:47], s49 offen offset:2048 lds
    buffer_load_dwordx4 v17, s[44:47], s49 offen offset:3072 lds
    s_lshr_b32 s64, s69, 1
    s_lshl_b32 s65, s35, 1
    s_add_u32 s64, s64, s65
    s_mul_i32 s65, s35, 3
    s_add_u32 s65, s65, s69
    s_sub_u32 s65, s65, 24
    s_cmp_ge_u32 s35, 24
    s_cselect_b32 s64, s65, s64
    s_cselect_b32 s95, s69, 0
    s_mul_i32 s65, s34, 72
    s_add_u32 s65, s65, s64
    s_cmp_eq_u32 s95, 3
    s_cselect_b32 s95, 576, s65
    s_cselect_b32 s65, 0, s65
    s_lshl_b32 s64, s65, 1
    s_and_b32 s64, s64, -4
    s_load_dword s4, s[12:13], s64
    s_load_dword s5, s[14:15], s64
    s_load_dword s6, s[24:25], s64
    s_mov_b32 s36, s32
    s_mov_b32 s37, s33
    s_mov_b32 s38, 19091456
    s_mov_b32 s39, 0x00020000
    v_bfe_u32 v30, v1, 3, 1
    v_lshlrev_b32 v30, 3, v30
    v_bfe_u32 v31, v1, 5, 1
    v_lshl_add_u32 v30, v31, 4, v30
    v_bfe_u32 v31, v1, 4, 1
    v_add_u32 v30, v30, v31
    v_mul_u32_u24 v30, 1152, v30
    v_lshrrev_b32 v31, 4, v1
    v_and_b32 v29, 7, v1
    v_xor_b32 v31, v31, v29
    v_lshl_add_u32 v18, v31, 4, v30
    v_xor_b32 v31, 64, v18
    v_add_u32 v19, 1280, v31
    v_add_u32 v20, 2560, v18
    v_add_u32 v21, 3840, v31
    s_and_b32 s65, s69, 1
    s_lshl_b32 s64, s65, 6
    v_lshrrev_b32 v30, 3, v1
    v_mul_u32_u24 v30, 1152, v30
    v_lshrrev_b32 v31, 4, v1
    v_and_b32 v29, 7, v1
    v_xor_b32 v31, v31, v29
    v_lshl_add_u32 v22, v31, 4, v30
    v_xor_b32 v22, s64, v22
    v_xor_b32 v31, 64, v22
    v_add_u32 v23, 8192, v31
    v_add_u32 v24, 16384, v22
    s_branch L_cut_h
L_comp:
    s_bitcmp1_b32 s97, 0
    s_cbranch_scc1 L_nowarm
    s_getpc_b64 s[64:65]
L_pc:
    s_add_u32 s64, s64, concat_heads__softmax_full_mha__ssm_conv_s5__prompt_kernel-L_pc
    s_addc_u32 s65, s65, -1
    s_mul_i32 s66, s3, 9216
    v_lshlrev_b32 v23, 7, v1
    v_add_u32 v23, s66, v23
    v_cmp_gt_u32 vcc, L_exit-concat_heads__softmax_full_mha__ssm_conv_s5__prompt_kernel, v23
    s_and_saveexec_b64 s[66:67], vcc
    s_cbranch_execz L_nowarm
    global_load_dword v17, v23, s[64:65]
    v_add_u32 v23, 8192, v23
    v_cmp_gt_u32 vcc, L_exit-concat_heads__softmax_full_mha__ssm_conv_s5__prompt_kernel, v23
    s_and_b64 exec, vcc, 0xff
    s_cbranch_execz L_nowarm
    global_load_dword v17, v23, s[64:65]
L_nowarm:
    s_mov_b64 exec, -1
    v_and_b32 v2, 31, v0
    v_bfe_u32 v3, v0, 5, 1
    v_bfe_u32 v24, v0, 2, 2
    v_bfe_u32 v25, v0, 4, 1
    v_lshlrev_b32 v25, 5, v25
    v_and_b32 v26, 3, v0
    v_lshl_add_u32 v25, v26, 3, v25
    v_bfe_u32 v26, v0, 3, 1
    v_bfe_u32 v27, v0, 1, 3
    s_and_b32 s56, s3, 1
    s_lshr_b32 s57, s3, 1
    s_waitcnt lgkmcnt(0)
    s_bitcmp1_b32 s97, 0
    s_cbranch_scc1 L_noidle
    s_mov_b32 s40, s26
    s_mov_b32 s41, s27
    s_mov_b32 s42, 1152
    s_mov_b32 s43, 0x00020000
    v_lshlrev_b32 v23, 7, v1
    buffer_load_dword v17, v23, s[40:43], 0 offen
L_noidle:
    s_mov_b32 s36, s32
    s_mov_b32 s37, s33
    s_mov_b32 s38, 19091456
    s_mov_b32 s39, 0x00020000
    s_or_b32 s60, s2, s3
    s_cmp_lg_u32 s60, 0
    s_cbranch_scc1 L_c_nn
    s_memrealtime s[60:61]
    s_waitcnt lgkmcnt(0)
    s_or_b32 s60, s60, 1
    s_mov_b64 exec, 1
    v_mov_b32 v176, s60
    v_mov_b32 v177, 0
    global_atomic_cmpswap v177, v[176:177], s[30:31] sc1
    s_mov_b64 exec, -1
L_c_nn:
    s_lshl_b32 s66, s56, 13
    s_add_u32 s66, s66, 65536
    v_lshlrev_b32 v30, 7, v2
    v_add_u32 v30, s66, v30
    v_or_b32 v31, 0, v3
    v_xor_b32 v31, v31, v27
    v_lshl_add_u32 v156, v31, 4, v30
    v_or_b32 v31, 2, v3
    v_xor_b32 v31, v31, v27
    v_lshl_add_u32 v157, v31, 4, v30
    v_or_b32 v31, 4, v3
    v_xor_b32 v31, v31, v27
    v_lshl_add_u32 v158, v31, 4, v30
    v_or_b32 v31, 6, v3
    v_xor_b32 v31, v31, v27
    v_lshl_add_u32 v159, v31, 4, v30
    v_and_b32 v28, 32, v25
    v_and_b32 v29, 1, v0
    v_lshl_add_u32 v28, v29, 4, v28
    v_bfe_u32 v29, v0, 1, 1
    v_lshl_add_u32 v28, v29, 3, v28
    s_cmp_ge_u32 s59, 9
    s_cselect_b64 vcc, -1, 0
    v_lshl_add_u32 v30, v3, 3, v24
    v_lshlrev_b32 v30, 8, v30
    v_cndmask_b32 v28, v28, v25, vcc
    v_add_u32 v30, v30, v28
    v_add_u32 v30, 65536, v30
    s_lshl_b32 s66, s57, 1
    s_add_u32 s63, s66, 0
    v_xor_b32 v31, s63, v24
    v_lshl_add_u32 v160, v31, 6, v30
    s_add_u32 s63, s66, 1
    v_xor_b32 v31, s63, v24
    v_lshl_add_u32 v161, v31, 6, v30
    v_mov_b64 v[192:193], 0
    v_mov_b64 v[194:195], 0
    s_nop 1
    v_mfma_f32_32x32x16_bf16 v[32:47], v[192:195], v[192:195], 0
    v_mfma_f32_32x32x16_bf16 v[48:63], v[192:195], v[192:195], 0
    v_mfma_f32_32x32x16_bf16 v[64:79], v[192:195], v[192:195], 0
    v_mfma_f32_32x32x16_bf16 v[80:95], v[192:195], v[192:195], 0
    s_lshl_b32 s67, s58, 2
    s_lshl_b32 s68, s56, 1
    s_add_u32 s67, s67, s68
    s_lshl_b32 s68, s59, 1
    s_add_u32 s68, s68, s57
    s_cmp_lt_u32 s68, 9
    s_cselect_b32 s21, 1051597459, 1.0
    s_lshl_b32 s19, s68, 18
    s_lshl_b32 s63, s67, 9
    s_add_u32 s19, s19, s63
    s_mul_i32 s63, s67, 36864
    s_sub_u32 s62, s68, 18
    s_lshl_b32 s62, s62, 11
    s_add_u32 s63, s63, s62
    s_add_u32 s63, s63, 4718592
    s_cmp_ge_u32 s59, 9
    s_cselect_b32 s19, s63, s19
    s_mov_b32 s62, 32768
    s_cselect_b32 s62, 9216, s62
    s_cselect_b32 s22, 4, 15
    s_cselect_b32 s23, 5, 4
    s_movk_i32 s55, 0x200
    s_cselect_b32 s55, 0x400, s55
    v_lshlrev_b32 v170, s22, v3
    v_lshlrev_b32 v28, s23, v2
    v_add_u32 v170, v28, v170
    v_add_u32 v172, s55, v170
    s_cmp_ge_u32 s68, 27
    s_cselect_b32 s19, 1073741824, s19
    s_bitcmp1_b32 s97, 0
    s_cselect_b32 s19, s19, 1073741824
    s_lshl_b32 s20, s58, 2
    s_add_u32 s20, s20, s3
    s_mul_i32 s20, s20, 73728
    s_cmp_ge_u32 s96, 6
    s_cselect_b32 s63, 27648, 0
    s_add_u32 s20, s20, s63
    s_mul_i32 s63, s96, 1536
    s_add_u32 s20, s20, s63
    s_add_u32 s20, s20, 9437184
    s_bitcmp1_b32 s97, 1
    s_cselect_b32 s20, s20, 1073741824
    v_mul_u32_u24 v190, 18432, v3
    v_lshl_add_u32 v190, v2, 4, v190
    s_lshl_b32 s18, s62, 1
    s_mov_b32 s22, s21
    s_mov_b32 s23, s21
    s_lshl_b32 s66, s3, 12
    s_add_u32 s66, s66, 32768
    v_lshlrev_b32 v30, 7, v2
    v_add_u32 v30, s66, v30
    v_or_b32 v31, 0, v3
    v_xor_b32 v31, v31, v27
    v_lshl_add_u32 v162, v31, 4, v30
    v_or_b32 v31, 2, v3
    v_xor_b32 v31, v31, v27
    v_lshl_add_u32 v163, v31, 4, v30
    v_or_b32 v31, 4, v3
    v_xor_b32 v31, v31, v27
    v_lshl_add_u32 v164, v31, 4, v30
    v_or_b32 v31, 6, v3
    v_xor_b32 v31, v31, v27
    v_lshl_add_u32 v165, v31, 4, v30
    v_lshlrev_b32 v30, 7, v2
    v_add_u32 v30, 49152, v30
    v_or_b32 v31, 0, v3
    v_xor_b32 v31, v31, v27
    v_lshl_add_u32 v166, v31, 4, v30
    v_or_b32 v31, 2, v3
    v_xor_b32 v31, v31, v27
    v_lshl_add_u32 v167, v31, 4, v30
    v_or_b32 v31, 4, v3
    v_xor_b32 v31, v31, v27
    v_lshl_add_u32 v168, v31, 4, v30
    v_or_b32 v31, 6, v3
    v_xor_b32 v31, v31, v27
    v_lshl_add_u32 v169, v31, 4, v30
    s_setprio 0
L_cut_c:
    s_barrier
    s_cmp_ge_u32 s59, 9
    s_cbranch_scc1 L_cv
    s_mov_b32 s60, 0
    s_mov_b32 s61, 2
    s_mov_b32 s64, 1155619
    ds_read_b128 v[192:195], v156 offset:0
    ds_read_b64_tr_b16 v[200:201], v160 offset:16384
    ds_read_b64_tr_b16 v[202:203], v160 offset:17408
    ds_read_b128 v[196:199], v156 offset:4096
    ds_read_b64_tr_b16 v[204:205], v161 offset:16384
    ds_read_b64_tr_b16 v[206:207], v161 offset:17408
    ds_read_b128 v[208:211], v157 offset:0
    ds_read_b64_tr_b16 v[216:217], v160 offset:20480
    ds_read_b64_tr_b16 v[218:219], v160 offset:21504
    ds_read_b128 v[212:215], v157 offset:4096
    ds_read_b64_tr_b16 v[220:221], v161 offset:20480
    ds_read_b64_tr_b16 v[222:223], v161 offset:21504
L_gl_35:
    s_waitcnt lgkmcnt(9)
    v_mfma_f32_32x32x16_bf16 v[32:47], v[200:203], v[192:195], v[32:47]
    ds_read_b128 v[224:227], v158 offset:0
    ds_read_b64_tr_b16 v[232:233], v160 offset:24576
    s_waitcnt lgkmcnt(10)
    v_mfma_f32_32x32x16_bf16 v[48:63], v[200:203], v[196:199], v[48:63]
    ds_read_b64_tr_b16 v[234:235], v160 offset:25600
    ds_read_b128 v[228:231], v158 offset:4096
    s_waitcnt lgkmcnt(10)
    v_mfma_f32_32x32x16_bf16 v[64:79], v[204:207], v[192:195], v[64:79]
    ds_read_b64_tr_b16 v[236:237], v161 offset:24576
    ds_read_b64_tr_b16 v[238:239], v161 offset:25600
    v_mfma_f32_32x32x16_bf16 v[80:95], v[204:207], v[196:199], v[80:95]
    s_waitcnt lgkmcnt(9)
    v_mfma_f32_32x32x16_bf16 v[32:47], v[216:219], v[208:211], v[32:47]
    ds_read_b128 v[240:243], v159 offset:0
    ds_read_b64_tr_b16 v[248:249], v160 offset:28672
    s_waitcnt lgkmcnt(10)
    v_mfma_f32_32x32x16_bf16 v[48:63], v[216:219], v[212:215], v[48:63]
    ds_read_b64_tr_b16 v[250:251], v160 offset:29696
    ds_read_b128 v[244:247], v159 offset:4096
    s_waitcnt lgkmcnt(10)
    v_mfma_f32_32x32x16_bf16 v[64:79], v[220:223], v[208:211], v[64:79]
    ds_read_b64_tr_b16 v[252:253], v161 offset:28672
    ds_read_b64_tr_b16 v[254:255], v161 offset:29696
    v_mfma_f32_32x32x16_bf16 v[80:95], v[220:223], v[212:215], v[80:95]
    s_cmp_eq_u32 s60, 8
    s_cbranch_scc1 L_gl_last_36
    s_waitcnt lgkmcnt(9)
    v_mfma_f32_32x32x16_bf16 v[32:47], v[232:235], v[224:227], v[32:47]
    s_and_b32 s65, s64, 7
    s_lshr_b32 s64, s64, 3
    s_sub_u32 s62, s65, s61
    s_lshl_b32 s62, s62, 15
    s_mov_b32 s61, s65
    s_waitcnt lgkmcnt(8)
    v_mfma_f32_32x32x16_bf16 v[48:63], v[232:235], v[228:231], v[48:63]
    s_waitcnt lgkmcnt(0)
    s_barrier
    v_add_u32 v156, s62, v156
    v_add_u32 v157, s62, v157
    v_add_u32 v158, s62, v158
    v_add_u32 v159, s62, v159
    v_add_u32 v160, s62, v160
    v_add_u32 v161, s62, v161
    v_mfma_f32_32x32x16_bf16 v[64:79], v[236:239], v[224:227], v[64:79]
    ds_read_b128 v[192:195], v156 offset:0
    ds_read_b64_tr_b16 v[200:201], v160 offset:16384
    v_mfma_f32_32x32x16_bf16 v[80:95], v[236:239], v[228:231], v[80:95]
    ds_read_b64_tr_b16 v[202:203], v160 offset:17408
    ds_read_b128 v[196:199], v156 offset:4096
    ds_read_b64_tr_b16 v[204:205], v161 offset:16384
    ds_read_b64_tr_b16 v[206:207], v161 offset:17408
    v_mfma_f32_32x32x16_bf16 v[32:47], v[248:251], v[240:243], v[32:47]
    ds_read_b128 v[208:211], v157 offset:0
    ds_read_b64_tr_b16 v[216:217], v160 offset:20480
    v_mfma_f32_32x32x16_bf16 v[48:63], v[248:251], v[244:247], v[48:63]
    ds_read_b64_tr_b16 v[218:219], v160 offset:21504
    ds_read_b128 v[212:215], v157 offset:4096
    v_mfma_f32_32x32x16_bf16 v[64:79], v[252:255], v[240:243], v[64:79]
    ds_read_b64_tr_b16 v[220:221], v161 offset:20480
    ds_read_b64_tr_b16 v[222:223], v161 offset:21504
    v_mfma_f32_32x32x16_bf16 v[80:95], v[252:255], v[244:247], v[80:95]
    s_add_u32 s60, s60, 1
    s_branch L_gl_35
L_gl_last_36:
    s_waitcnt lgkmcnt(9)
    v_mfma_f32_32x32x16_bf16 v[32:47], v[232:235], v[224:227], v[32:47]
    s_waitcnt lgkmcnt(8)
    v_mfma_f32_32x32x16_bf16 v[48:63], v[232:235], v[228:231], v[48:63]
    s_waitcnt lgkmcnt(6)
    v_mfma_f32_32x32x16_bf16 v[64:79], v[236:239], v[224:227], v[64:79]
    v_mfma_f32_32x32x16_bf16 v[80:95], v[236:239], v[228:231], v[80:95]
    s_waitcnt lgkmcnt(0)
    s_barrier
    v_mfma_f32_32x32x16_bf16 v[32:47], v[248:251], v[240:243], v[32:47]
    ds_read_b128 v[192:195], v162 offset:0
    ds_read_b128 v[196:199], v166 offset:0
    v_mfma_f32_32x32x16_bf16 v[48:63], v[248:251], v[244:247], v[48:63]
    ds_read_b128 v[200:203], v166 offset:4096
    ds_read_b128 v[204:207], v166 offset:8192
    v_mfma_f32_32x32x16_bf16 v[64:79], v[252:255], v[240:243], v[64:79]
    ds_read_b128 v[208:211], v163 offset:0
    ds_read_b128 v[212:215], v167 offset:0
    v_mfma_f32_32x32x16_bf16 v[80:95], v[252:255], v[244:247], v[80:95]
    ds_read_b128 v[216:219], v167 offset:4096
    ds_read_b128 v[220:223], v167 offset:8192
    s_branch L_cu
L_cv:
    s_mov_b32 s60, 0
    s_mov_b32 s61, 2
    s_mov_b32 s64, 1155619
    ds_read_b128 v[192:195], v156 offset:0
    ds_read_b64_tr_b16 v[200:201], v160 offset:16384
    ds_read_b64_tr_b16 v[202:203], v160 offset:17408
    ds_read_b128 v[196:199], v156 offset:4096
    ds_read_b64_tr_b16 v[204:205], v161 offset:16384
    ds_read_b64_tr_b16 v[206:207], v161 offset:17408
    ds_read_b128 v[208:211], v157 offset:0
    ds_read_b64_tr_b16 v[216:217], v160 offset:20480
    ds_read_b64_tr_b16 v[218:219], v160 offset:21504
    ds_read_b128 v[212:215], v157 offset:4096
    ds_read_b64_tr_b16 v[220:221], v161 offset:20480
    ds_read_b64_tr_b16 v[222:223], v161 offset:21504
L_gl_37:
    s_waitcnt lgkmcnt(9)
    v_mfma_f32_32x32x16_bf16 v[32:47], v[192:195], v[200:203], v[32:47]
    ds_read_b128 v[224:227], v158 offset:0
    ds_read_b64_tr_b16 v[232:233], v160 offset:24576
    s_waitcnt lgkmcnt(10)
    v_mfma_f32_32x32x16_bf16 v[64:79], v[196:199], v[200:203], v[64:79]
    ds_read_b64_tr_b16 v[234:235], v160 offset:25600
    ds_read_b128 v[228:231], v158 offset:4096
    s_waitcnt lgkmcnt(10)
    v_mfma_f32_32x32x16_bf16 v[48:63], v[192:195], v[204:207], v[48:63]
    ds_read_b64_tr_b16 v[236:237], v161 offset:24576
    ds_read_b64_tr_b16 v[238:239], v161 offset:25600
    v_mfma_f32_32x32x16_bf16 v[80:95], v[196:199], v[204:207], v[80:95]
    s_waitcnt lgkmcnt(9)
    v_mfma_f32_32x32x16_bf16 v[32:47], v[208:211], v[216:219], v[32:47]
    ds_read_b128 v[240:243], v159 offset:0
    ds_read_b64_tr_b16 v[248:249], v160 offset:28672
    s_waitcnt lgkmcnt(10)
    v_mfma_f32_32x32x16_bf16 v[64:79], v[212:215], v[216:219], v[64:79]
    ds_read_b64_tr_b16 v[250:251], v160 offset:29696
    ds_read_b128 v[244:247], v159 offset:4096
    s_waitcnt lgkmcnt(10)
    v_mfma_f32_32x32x16_bf16 v[48:63], v[208:211], v[220:223], v[48:63]
    ds_read_b64_tr_b16 v[252:253], v161 offset:28672
    ds_read_b64_tr_b16 v[254:255], v161 offset:29696
    v_mfma_f32_32x32x16_bf16 v[80:95], v[212:215], v[220:223], v[80:95]
    s_cmp_eq_u32 s60, 8
    s_cbranch_scc1 L_gl_last_38
    s_waitcnt lgkmcnt(9)
    v_mfma_f32_32x32x16_bf16 v[32:47], v[224:227], v[232:235], v[32:47]
    s_and_b32 s65, s64, 7
    s_lshr_b32 s64, s64, 3
    s_sub_u32 s62, s65, s61
    s_lshl_b32 s62, s62, 15
    s_mov_b32 s61, s65
    s_waitcnt lgkmcnt(8)
    v_mfma_f32_32x32x16_bf16 v[64:79], v[228:231], v[232:235], v[64:79]
    s_waitcnt lgkmcnt(0)
    s_barrier
    v_add_u32 v156, s62, v156
    v_add_u32 v157, s62, v157
    v_add_u32 v158, s62, v158
    v_add_u32 v159, s62, v159
    v_add_u32 v160, s62, v160
    v_add_u32 v161, s62, v161
    v_mfma_f32_32x32x16_bf16 v[48:63], v[224:227], v[236:239], v[48:63]
    ds_read_b128 v[192:195], v156 offset:0
    ds_read_b64_tr_b16 v[200:201], v160 offset:16384
    v_mfma_f32_32x32x16_bf16 v[80:95], v[228:231], v[236:239], v[80:95]
    ds_read_b64_tr_b16 v[202:203], v160 offset:17408
    ds_read_b128 v[196:199], v156 offset:4096
    ds_read_b64_tr_b16 v[204:205], v161 offset:16384
    ds_read_b64_tr_b16 v[206:207], v161 offset:17408
    v_mfma_f32_32x32x16_bf16 v[32:47], v[240:243], v[248:251], v[32:47]
    ds_read_b128 v[208:211], v157 offset:0
    ds_read_b64_tr_b16 v[216:217], v160 offset:20480
    v_mfma_f32_32x32x16_bf16 v[64:79], v[244:247], v[248:251], v[64:79]
    ds_read_b64_tr_b16 v[218:219], v160 offset:21504
    ds_read_b128 v[212:215], v157 offset:4096
    v_mfma_f32_32x32x16_bf16 v[48:63], v[240:243], v[252:255], v[48:63]
    ds_read_b64_tr_b16 v[220:221], v161 offset:20480
    ds_read_b64_tr_b16 v[222:223], v161 offset:21504
    v_mfma_f32_32x32x16_bf16 v[80:95], v[244:247], v[252:255], v[80:95]
    s_add_u32 s60, s60, 1
    s_branch L_gl_37
L_gl_last_38:
    s_waitcnt lgkmcnt(9)
    v_mfma_f32_32x32x16_bf16 v[32:47], v[224:227], v[232:235], v[32:47]
    s_waitcnt lgkmcnt(8)
    v_mfma_f32_32x32x16_bf16 v[64:79], v[228:231], v[232:235], v[64:79]
    s_waitcnt lgkmcnt(6)
    v_mfma_f32_32x32x16_bf16 v[48:63], v[224:227], v[236:239], v[48:63]
    v_mfma_f32_32x32x16_bf16 v[80:95], v[228:231], v[236:239], v[80:95]
    s_waitcnt lgkmcnt(0)
    s_barrier
    v_mfma_f32_32x32x16_bf16 v[32:47], v[240:243], v[248:251], v[32:47]
    ds_read_b128 v[192:195], v162 offset:0
    ds_read_b128 v[196:199], v166 offset:0
    v_mfma_f32_32x32x16_bf16 v[64:79], v[244:247], v[248:251], v[64:79]
    ds_read_b128 v[200:203], v166 offset:4096
    ds_read_b128 v[204:207], v166 offset:8192
    v_mfma_f32_32x32x16_bf16 v[48:63], v[240:243], v[252:255], v[48:63]
    ds_read_b128 v[208:211], v163 offset:0
    ds_read_b128 v[212:215], v167 offset:0
    v_mfma_f32_32x32x16_bf16 v[80:95], v[244:247], v[252:255], v[80:95]
    ds_read_b128 v[216:219], v167 offset:4096
    ds_read_b128 v[220:223], v167 offset:8192
L_cu:
    s_nop 12
    v_pk_mul_f32 v[32:33], v[32:33], s[22:23]
    v_pk_mul_f32 v[34:35], v[34:35], s[22:23]
    v_pk_mul_f32 v[36:37], v[36:37], s[22:23]
    v_pk_mul_f32 v[38:39], v[38:39], s[22:23]
    v_cvt_pk_bf16_f32 v32, v32, v33
    v_cvt_pk_bf16_f32 v33, v34, v35
    v_cvt_pk_bf16_f32 v34, v36, v37
    v_cvt_pk_bf16_f32 v35, v38, v39
    buffer_store_dwordx4 v[32:35], v170, s[36:39], s19 offen sc1
    v_pk_mul_f32 v[48:49], v[48:49], s[22:23]
    v_pk_mul_f32 v[50:51], v[50:51], s[22:23]
    v_pk_mul_f32 v[52:53], v[52:53], s[22:23]
    v_pk_mul_f32 v[54:55], v[54:55], s[22:23]
    v_cvt_pk_bf16_f32 v48, v48, v49
    v_cvt_pk_bf16_f32 v49, v50, v51
    v_cvt_pk_bf16_f32 v50, v52, v53
    v_cvt_pk_bf16_f32 v51, v54, v55
    buffer_store_dwordx4 v[48:51], v172, s[36:39], s19 offen sc1
    s_add_u32 s19, s19, s18
    v_pk_mul_f32 v[40:41], v[40:41], s[22:23]
    v_pk_mul_f32 v[42:43], v[42:43], s[22:23]
    v_pk_mul_f32 v[44:45], v[44:45], s[22:23]
    v_pk_mul_f32 v[46:47], v[46:47], s[22:23]
    v_cvt_pk_bf16_f32 v40, v40, v41
    v_cvt_pk_bf16_f32 v41, v42, v43
    v_cvt_pk_bf16_f32 v42, v44, v45
    v_cvt_pk_bf16_f32 v43, v46, v47
    buffer_store_dwordx4 v[40:43], v170, s[36:39], s19 offen sc1
    v_pk_mul_f32 v[56:57], v[56:57], s[22:23]
    v_pk_mul_f32 v[58:59], v[58:59], s[22:23]
    v_pk_mul_f32 v[60:61], v[60:61], s[22:23]
    v_pk_mul_f32 v[62:63], v[62:63], s[22:23]
    v_cvt_pk_bf16_f32 v56, v56, v57
    v_cvt_pk_bf16_f32 v57, v58, v59
    v_cvt_pk_bf16_f32 v58, v60, v61
    v_cvt_pk_bf16_f32 v59, v62, v63
    buffer_store_dwordx4 v[56:59], v172, s[36:39], s19 offen sc1
    s_add_u32 s19, s19, s18
    v_pk_mul_f32 v[64:65], v[64:65], s[22:23]
    v_pk_mul_f32 v[66:67], v[66:67], s[22:23]
    v_pk_mul_f32 v[68:69], v[68:69], s[22:23]
    v_pk_mul_f32 v[70:71], v[70:71], s[22:23]
    v_cvt_pk_bf16_f32 v64, v64, v65
    v_cvt_pk_bf16_f32 v65, v66, v67
    v_cvt_pk_bf16_f32 v66, v68, v69
    v_cvt_pk_bf16_f32 v67, v70, v71
    buffer_store_dwordx4 v[64:67], v170, s[36:39], s19 offen sc1
    v_pk_mul_f32 v[80:81], v[80:81], s[22:23]
    v_pk_mul_f32 v[82:83], v[82:83], s[22:23]
    v_pk_mul_f32 v[84:85], v[84:85], s[22:23]
    v_pk_mul_f32 v[86:87], v[86:87], s[22:23]
    v_cvt_pk_bf16_f32 v80, v80, v81
    v_cvt_pk_bf16_f32 v81, v82, v83
    v_cvt_pk_bf16_f32 v82, v84, v85
    v_cvt_pk_bf16_f32 v83, v86, v87
    buffer_store_dwordx4 v[80:83], v172, s[36:39], s19 offen sc1
    s_add_u32 s19, s19, s18
    v_pk_mul_f32 v[72:73], v[72:73], s[22:23]
    v_pk_mul_f32 v[74:75], v[74:75], s[22:23]
    v_pk_mul_f32 v[76:77], v[76:77], s[22:23]
    v_pk_mul_f32 v[78:79], v[78:79], s[22:23]
    v_cvt_pk_bf16_f32 v72, v72, v73
    v_cvt_pk_bf16_f32 v73, v74, v75
    v_cvt_pk_bf16_f32 v74, v76, v77
    v_cvt_pk_bf16_f32 v75, v78, v79
    buffer_store_dwordx4 v[72:75], v170, s[36:39], s19 offen sc1
    v_pk_mul_f32 v[88:89], v[88:89], s[22:23]
    v_pk_mul_f32 v[90:91], v[90:91], s[22:23]
    v_pk_mul_f32 v[92:93], v[92:93], s[22:23]
    v_pk_mul_f32 v[94:95], v[94:95], s[22:23]
    v_cvt_pk_bf16_f32 v88, v88, v89
    v_cvt_pk_bf16_f32 v89, v90, v91
    v_cvt_pk_bf16_f32 v90, v92, v93
    v_cvt_pk_bf16_f32 v91, v94, v95
    buffer_store_dwordx4 v[88:91], v172, s[36:39], s19 offen sc1
    s_add_u32 s19, s19, s18
    s_waitcnt lgkmcnt(4)
    v_mfma_f32_32x32x16_bf16 v[96:111], v[192:195], v[196:199], 0
    ds_read_b128 v[224:227], v164 offset:0
    ds_read_b128 v[228:231], v168 offset:0
    s_lshl_b32 s40, s34, 2
    s_lshr_b32 s41, s35, 3
    v_mfma_f32_32x32x16_bf16 v[112:127], v[192:195], v[200:203], 0
    ds_read_b128 v[232:235], v168 offset:4096
    ds_read_b128 v[236:239], v168 offset:8192
    s_add_u32 s40, s40, s41
    s_and_b32 s95, s35, 7
    v_mfma_f32_32x32x16_bf16 v[128:143], v[192:195], v[204:207], 0
    s_mul_i32 s42, s40, 9
    s_lshr_b32 s42, s42, 2
    s_waitcnt lgkmcnt(4)
    v_mfma_f32_32x32x16_bf16 v[96:111], v[208:211], v[212:215], v[96:111]
    ds_read_b128 v[240:243], v165 offset:0
    ds_read_b128 v[244:247], v169 offset:0
    s_and_b32 s45, s40, 3
    s_lshr_b32 s46, s45, 1
    v_mfma_f32_32x32x16_bf16 v[112:127], v[208:211], v[216:219], v[112:127]
    ds_read_b128 v[248:251], v169 offset:4096
    ds_read_b128 v[252:255], v169 offset:8192
    s_add_u32 s43, s42, s46
    s_xor_b32 s44, s46, 1
    v_mfma_f32_32x32x16_bf16 v[128:143], v[208:211], v[220:223], v[128:143]
    s_lshl_b32 s44, s44, 1
    s_add_u32 s44, s44, s42
    s_waitcnt lgkmcnt(4)
    v_mfma_f32_32x32x16_bf16 v[96:111], v[224:227], v[228:231], v[96:111]
    s_waitcnt lgkmcnt(0)
    s_barrier
    v_add_u32 v162, 32768, v162
    v_add_u32 v163, 32768, v163
    v_add_u32 v164, 32768, v164
    v_add_u32 v165, 32768, v165
    v_add_u32 v166, 32768, v166
    v_add_u32 v167, 32768, v167
    v_add_u32 v168, 32768, v168
    v_add_u32 v169, 32768, v169
    ds_read_b128 v[192:195], v162 offset:0
    ds_read_b128 v[196:199], v166 offset:0
    s_lshl_b32 s44, s44, 15
    s_lshl_b32 s46, s46, 3
    v_mfma_f32_32x32x16_bf16 v[112:127], v[224:227], v[232:235], v[112:127]
    ds_read_b128 v[200:203], v166 offset:4096
    ds_read_b128 v[204:207], v166 offset:8192
    s_add_u32 s44, s44, s46
    s_and_b32 s24, s34, 3
    v_mfma_f32_32x32x16_bf16 v[128:143], v[224:227], v[236:239], v[128:143]
    s_lshl_b32 s24, s24, 3
    s_and_b32 s25, s35, 7
    v_mfma_f32_32x32x16_bf16 v[96:111], v[240:243], v[244:247], v[96:111]
    ds_read_b128 v[208:211], v163 offset:0
    ds_read_b128 v[212:215], v167 offset:0
    s_add_u32 s24, s24, s25
    s_lshr_b32 s25, s34, 2
    v_mfma_f32_32x32x16_bf16 v[112:127], v[240:243], v[248:251], v[112:127]
    ds_read_b128 v[216:219], v167 offset:4096
    ds_read_b128 v[220:223], v167 offset:8192
    s_mul_i32 s25, s25, 3
    s_lshr_b32 s60, s35, 3
    v_mfma_f32_32x32x16_bf16 v[128:143], v[240:243], v[252:255], v[128:143]
    s_add_u32 s25, s25, s60
    s_lshr_b32 s66, s24, 1
    s_waitcnt lgkmcnt(4)
    v_mfma_f32_32x32x16_bf16 v[96:111], v[192:195], v[196:199], v[96:111]
    ds_read_b128 v[224:227], v164 offset:0
    ds_read_b128 v[228:231], v168 offset:0
    s_lshl_b32 s66, s66, 7
    s_lshl_b32 s67, s56, 6
    s_add_u32 s66, s66, s67
    s_lshl_b32 s67, s57, 5
    v_mfma_f32_32x32x16_bf16 v[112:127], v[192:195], v[200:203], v[112:127]
    ds_read_b128 v[232:235], v168 offset:4096
    ds_read_b128 v[236:239], v168 offset:8192
    s_add_u32 s66, s66, s67
    s_and_b32 s67, s24, 1
    s_lshl_b32 s67, s67, 2
    s_add_u32 s66, s66, s67
    v_mfma_f32_32x32x16_bf16 v[128:143], v[192:195], v[204:207], v[128:143]
    s_mul_i32 s16, s66, 1152
    s_mul_i32 s17, s25, 192
    s_add_u32 s16, s16, s17
    s_mul_i32 s12, s66, 4608
    s_waitcnt lgkmcnt(4)
    v_mfma_f32_32x32x16_bf16 v[96:111], v[208:211], v[212:215], v[96:111]
    ds_read_b128 v[240:243], v165 offset:0
    ds_read_b128 v[244:247], v169 offset:0
    s_mul_i32 s68, s25, 384
    s_add_u32 s12, s12, s68
    s_add_u32 s12, s12, 2304
    s_lshl_b32 s13, s24, 6
    v_mfma_f32_32x32x16_bf16 v[112:127], v[208:211], v[216:219], v[112:127]
    ds_read_b128 v[248:251], v169 offset:4096
    ds_read_b128 v[252:255], v169 offset:8192
    s_lshl_b32 s67, s56, 5
    s_add_u32 s13, s13, s67
    s_lshl_b32 s67, s57, 4
    s_add_u32 s13, s13, s67
    v_mfma_f32_32x32x16_bf16 v[128:143], v[208:211], v[220:223], v[128:143]
    s_mul_i32 s13, s13, 4608
    s_add_u32 s13, s13, s68
    s_lshl_b32 s14, s95, 2
    s_add_u32 s14, s14, s3
    s_waitcnt lgkmcnt(4)
    v_mfma_f32_32x32x16_bf16 v[96:111], v[224:227], v[228:231], v[96:111]
    s_waitcnt vmcnt(0)
    s_waitcnt lgkmcnt(0)
    s_barrier
    v_add_u32 v162, 32768, v162
    v_add_u32 v163, 32768, v163
    v_add_u32 v164, 32768, v164
    v_add_u32 v165, 32768, v165
    v_add_u32 v166, 32768, v166
    v_add_u32 v167, 32768, v167
    v_add_u32 v168, 32768, v168
    v_add_u32 v169, 32768, v169
    ds_read_b128 v[192:195], v162 offset:0
    ds_read_b128 v[196:199], v166 offset:0
    s_lshl_b32 s14, s14, 12
    v_mfma_f32_32x32x16_bf16 v[112:127], v[224:227], v[232:235], v[112:127]
    ds_read_b128 v[200:203], v166 offset:4096
    ds_read_b128 v[204:207], v166 offset:8192
    v_mfma_f32_32x32x16_bf16 v[128:143], v[224:227], v[236:239], v[128:143]
    v_mfma_f32_32x32x16_bf16 v[96:111], v[240:243], v[244:247], v[96:111]
    ds_read_b128 v[208:211], v163 offset:0
    ds_read_b128 v[212:215], v167 offset:0
    v_mfma_f32_32x32x16_bf16 v[112:127], v[240:243], v[248:251], v[112:127]
    ds_read_b128 v[216:219], v167 offset:4096
    ds_read_b128 v[220:223], v167 offset:8192
    v_mfma_f32_32x32x16_bf16 v[128:143], v[240:243], v[252:255], v[128:143]
    s_waitcnt lgkmcnt(4)
    v_mfma_f32_32x32x16_bf16 v[96:111], v[192:195], v[196:199], v[96:111]
    ds_read_b128 v[224:227], v164 offset:0
    ds_read_b128 v[228:231], v168 offset:0
    s_lshl_b32 s63, s40, 7
    s_add_u32 s14, s14, s63
    v_mfma_f32_32x32x16_bf16 v[112:127], v[192:195], v[200:203], v[112:127]
    ds_read_b128 v[232:235], v168 offset:4096
    ds_read_b128 v[236:239], v168 offset:8192
    s_add_u32 s14, s14, 18960384
    s_lshl_b32 s66, s57, 13
    v_mfma_f32_32x32x16_bf16 v[128:143], v[192:195], v[204:207], v[128:143]
    s_lshl_b32 s62, s57, 5
    v_lshl_add_u32 v30, v3, 3, v24
    s_waitcnt lgkmcnt(4)
    v_mfma_f32_32x32x16_bf16 v[96:111], v[208:211], v[212:215], v[96:111]
    ds_read_b128 v[240:243], v165 offset:0
    ds_read_b128 v[244:247], v169 offset:0
    v_lshlrev_b32 v29, 7, v30
    v_xor_b32 v31, s62, v25
    v_mfma_f32_32x32x16_bf16 v[112:127], v[208:211], v[216:219], v[112:127]
    ds_read_b128 v[248:251], v169 offset:4096
    ds_read_b128 v[252:255], v169 offset:8192
    v_add_u32 v29, v29, v31
    v_xor_b32 v31, s56, v26
    v_mfma_f32_32x32x16_bf16 v[128:143], v[208:211], v[220:223], v[128:143]
    v_lshl_add_u32 v29, v31, 6, v29
    v_add_u32 v188, s66, v29
    s_waitcnt lgkmcnt(4)
    v_mfma_f32_32x32x16_bf16 v[96:111], v[224:227], v[228:231], v[96:111]
    s_waitcnt lgkmcnt(0)
    s_barrier
    v_add_u32 v162, 32768, v162
    v_add_u32 v163, 32768, v163
    v_add_u32 v164, 32768, v164
    v_add_u32 v165, 32768, v165
    v_add_u32 v166, 32768, v166
    v_add_u32 v167, 32768, v167
    v_add_u32 v168, 32768, v168
    v_add_u32 v169, 32768, v169
    ds_read_b128 v[192:195], v162 offset:0
    ds_read_b128 v[196:199], v166 offset:0
    v_mul_u32_u24 v29, 192, v30
    v_add_u32 v29, v29, v25
    v_mfma_f32_32x32x16_bf16 v[112:127], v[224:227], v[232:235], v[112:127]
    ds_read_b128 v[200:203], v166 offset:4096
    ds_read_b128 v[204:207], v166 offset:8192
    s_mul_i32 s63, s57, 12288
    s_add_u32 s62, s63, 40960
    v_mfma_f32_32x32x16_bf16 v[128:143], v[224:227], v[236:239], v[128:143]
    v_add_u32 v5, s62, v29
    s_lshl_b32 s62, s57, 4
    v_mfma_f32_32x32x16_bf16 v[96:111], v[240:243], v[244:247], v[96:111]
    ds_read_b128 v[208:211], v163 offset:0
    ds_read_b128 v[212:215], v167 offset:0
    v_xor_b32 v31, s62, v2
    v_lshlrev_b32 v29, 10, v3
    v_mfma_f32_32x32x16_bf16 v[112:127], v[240:243], v[248:251], v[112:127]
    ds_read_b128 v[216:219], v167 offset:4096
    ds_read_b128 v[220:223], v167 offset:8192
    v_lshl_add_u32 v29, v31, 4, v29
    s_lshl_b32 s62, s56, 9
    v_mfma_f32_32x32x16_bf16 v[128:143], v[240:243], v[252:255], v[128:143]
    s_add_u32 s62, s62, s66
    s_add_u32 s62, s62, 40960
    s_waitcnt lgkmcnt(4)
    v_mfma_f32_32x32x16_bf16 v[96:111], v[192:195], v[196:199], v[96:111]
    ds_read_b128 v[224:227], v164 offset:0
    ds_read_b128 v[228:231], v168 offset:0
    v_add_u32 v4, s62, v29
    s_add_u32 s66, s63, 16384
    v_lshlrev_b32 v30, 7, v2
    v_add_u32 v30, s66, v30
    v_mfma_f32_32x32x16_bf16 v[112:127], v[192:195], v[200:203], v[112:127]
    ds_read_b128 v[232:235], v168 offset:4096
    ds_read_b128 v[236:239], v168 offset:8192
    v_or_b32 v31, 0, v3
    v_xor_b32 v31, v31, v27
    v_lshl_add_u32 v184, v31, 4, v30
    v_or_b32 v31, 2, v3
    v_mfma_f32_32x32x16_bf16 v[128:143], v[192:195], v[204:207], v[128:143]
    v_xor_b32 v31, v31, v27
    v_lshl_add_u32 v185, v31, 4, v30
    v_or_b32 v31, 4, v3
    v_xor_b32 v31, v31, v27
    s_waitcnt lgkmcnt(4)
    v_mfma_f32_32x32x16_bf16 v[96:111], v[208:211], v[212:215], v[96:111]
    ds_read_b128 v[240:243], v165 offset:0
    ds_read_b128 v[244:247], v169 offset:0
    v_lshl_add_u32 v186, v31, 4, v30
    v_or_b32 v31, 6, v3
    v_xor_b32 v31, v31, v27
    v_lshl_add_u32 v187, v31, 4, v30
    v_mfma_f32_32x32x16_bf16 v[112:127], v[208:211], v[216:219], v[112:127]
    ds_read_b128 v[248:251], v169 offset:4096
    ds_read_b128 v[252:255], v169 offset:8192
    s_mul_i32 s63, s3, 6144
    v_lshlrev_b32 v28, 4, v1
    v_add_u32 v6, s63, v28
    s_xor_b32 s63, s3, 2
    v_mfma_f32_32x32x16_bf16 v[128:143], v[208:211], v[220:223], v[128:143]
    s_mul_i32 s63, s63, 6144
    v_add_u32 v7, s63, v28
    s_lshl_b32 s46, s95, 3
    s_lshl_b32 s47, s3, 1
    s_waitcnt lgkmcnt(4)
    v_mfma_f32_32x32x16_bf16 v[96:111], v[224:227], v[228:231], v[96:111]
    s_waitcnt lgkmcnt(0)
    s_barrier
    v_add_u32 v162, 4294836224, v162
    v_add_u32 v163, 4294836224, v163
    v_add_u32 v164, 4294836224, v164
    v_add_u32 v165, 4294836224, v165
    v_add_u32 v166, 4294836224, v166
    v_add_u32 v167, 4294836224, v167
    v_add_u32 v168, 4294836224, v168
    v_add_u32 v169, 4294836224, v169
    ds_read_b128 v[192:195], v162 offset:0
    ds_read_b128 v[196:199], v166 offset:0
    s_add_u32 s46, s46, s47
    v_mfma_f32_32x32x16_bf16 v[112:127], v[224:227], v[232:235], v[112:127]
    ds_read_b128 v[200:203], v166 offset:4096
    ds_read_b128 v[204:207], v166 offset:8192
    v_mfma_f32_32x32x16_bf16 v[128:143], v[224:227], v[236:239], v[128:143]
    v_mfma_f32_32x32x16_bf16 v[96:111], v[240:243], v[244:247], v[96:111]
    ds_read_b128 v[208:211], v163 offset:0
    ds_read_b128 v[212:215], v167 offset:0
    v_mfma_f32_32x32x16_bf16 v[112:127], v[240:243], v[248:251], v[112:127]
    ds_read_b128 v[216:219], v167 offset:4096
    ds_read_b128 v[220:223], v167 offset:8192
    v_mfma_f32_32x32x16_bf16 v[128:143], v[240:243], v[252:255], v[128:143]
    s_waitcnt lgkmcnt(4)
    v_mfma_f32_32x32x16_bf16 v[96:111], v[192:195], v[196:199], v[96:111]
    ds_read_b128 v[224:227], v164 offset:0
    ds_read_b128 v[228:231], v168 offset:0
    s_lshl_b32 s47, s46, 9
    s_lshl_b32 s48, s43, 15
    v_mfma_f32_32x32x16_bf16 v[112:127], v[192:195], v[200:203], v[112:127]
    ds_read_b128 v[232:235], v168 offset:4096
    ds_read_b128 v[236:239], v168 offset:8192
    s_add_u32 s48, s48, s47
    s_add_u32 s49, s44, s47
    v_mfma_f32_32x32x16_bf16 v[128:143], v[192:195], v[204:207], v[128:143]
    v_lshlrev_b32 v10, 4, v1
    v_lshlrev_b32 v13, 15, v3
    s_waitcnt lgkmcnt(4)
    v_mfma_f32_32x32x16_bf16 v[96:111], v[208:211], v[212:215], v[96:111]
    ds_read_b128 v[240:243], v165 offset:0
    ds_read_b128 v[244:247], v169 offset:0
    v_lshl_add_u32 v13, v2, 4, v13
    v_lshlrev_b32 v14, 30, v3
    v_mfma_f32_32x32x16_bf16 v[112:127], v[208:211], v[216:219], v[112:127]
    ds_read_b128 v[248:251], v169 offset:4096
    ds_read_b128 v[252:255], v169 offset:8192
    v_lshl_add_u32 v14, v2, 4, v14
    v_lshlrev_b32 v11, 4, v2
    v_mfma_f32_32x32x16_bf16 v[128:143], v[208:211], v[220:223], v[128:143]
    v_add_u32 v11, 8192, v11
    v_mov_b32 v8, 0x8000
    s_waitcnt lgkmcnt(4)
    v_mfma_f32_32x32x16_bf16 v[96:111], v[224:227], v[228:231], v[96:111]
    s_waitcnt lgkmcnt(0)
    s_barrier
    v_add_u32 v162, 32768, v162
    v_add_u32 v163, 32768, v163
    v_add_u32 v164, 32768, v164
    v_add_u32 v165, 32768, v165
    v_add_u32 v166, 32768, v166
    v_add_u32 v167, 32768, v167
    v_add_u32 v168, 32768, v168
    v_add_u32 v169, 32768, v169
    ds_read_b128 v[192:195], v162 offset:0
    ds_read_b128 v[196:199], v166 offset:0
    v_cmp_gt_u32 vcc, 19, v2
    v_mul_u32_u24 v9, 304, v3
    v_mfma_f32_32x32x16_bf16 v[112:127], v[224:227], v[232:235], v[112:127]
    ds_read_b128 v[200:203], v166 offset:4096
    ds_read_b128 v[204:207], v166 offset:8192
    s_nop 0
    v_cndmask_b32 v8, v8, v2, vcc
    v_mfma_f32_32x32x16_bf16 v[128:143], v[224:227], v[236:239], v[128:143]
    v_cmp_eq_u32 vcc, 28, v2
    s_nop 1
    v_mfma_f32_32x32x16_bf16 v[96:111], v[240:243], v[244:247], v[96:111]
    ds_read_b128 v[208:211], v163 offset:0
    ds_read_b128 v[212:215], v167 offset:0
    v_cndmask_b32 v8, v8, 18, vcc
    v_lshl_add_u32 v15, v8, 4, v9
    v_mfma_f32_32x32x16_bf16 v[112:127], v[240:243], v[248:251], v[112:127]
    ds_read_b128 v[216:219], v167 offset:4096
    ds_read_b128 v[220:223], v167 offset:8192
    v_add_u32 v12, 10240, v15
    v_mul_u32_u24 v8, 9216, v3
    v_mfma_f32_32x32x16_bf16 v[128:143], v[240:243], v[252:255], v[128:143]
    v_lshl_add_u32 v8, v2, 2, v8
    v_mul_u32_u24 v9, 18432, v3
    s_waitcnt lgkmcnt(4)
    v_mfma_f32_32x32x16_bf16 v[96:111], v[192:195], v[196:199], v[96:111]
    ds_read_b128 v[224:227], v164 offset:0
    ds_read_b128 v[228:231], v168 offset:0
    v_lshl_add_u32 v9, v2, 2, v9
    v_mov_b64 v[180:181], 0
    v_mov_b64 v[182:183], 0
    s_lshl_b32 s62, s3, 2
    v_mfma_f32_32x32x16_bf16 v[112:127], v[192:195], v[200:203], v[112:127]
    ds_read_b128 v[232:235], v168 offset:4096
    ds_read_b128 v[236:239], v168 offset:8192
    s_add_u32 s62, s62, 163808
    v_mul_u32_u24 v191, 0x100004, v1
    v_add_u32 v191, s62, v191
    s_mov_b32 s52, s26
    v_mfma_f32_32x32x16_bf16 v[128:143], v[192:195], v[204:207], v[128:143]
    s_mov_b32 s53, s27
    s_mov_b32 s54, 1152
    s_mov_b32 s55, 0x00020000
    v_lshlrev_b32 v29, 1, v2
    s_waitcnt lgkmcnt(4)
    v_mfma_f32_32x32x16_bf16 v[96:111], v[208:211], v[212:215], v[96:111]
    ds_read_b128 v[240:243], v165 offset:0
    ds_read_b128 v[244:247], v169 offset:0
    buffer_load_ushort v176, v29, s[52:55], s17 offen
    buffer_load_ushort v177, v29, s[52:55], s17 offen offset:64
    buffer_load_ushort v178, v29, s[52:55], s17 offen offset:128
    s_lshl_b32 s62, s57, 4
    v_mfma_f32_32x32x16_bf16 v[112:127], v[208:211], v[216:219], v[112:127]
    ds_read_b128 v[248:251], v169 offset:4096
    ds_read_b128 v[252:255], v169 offset:8192
    v_xor_b32 v31, s62, v2
    v_lshrrev_b32 v28, 3, v31
    v_lshlrev_b32 v28, 4, v28
    v_bfe_u32 v29, v31, 1, 2
    v_mfma_f32_32x32x16_bf16 v[128:143], v[208:211], v[220:223], v[128:143]
    v_add_u32 v28, v28, v29
    v_and_b32 v29, 1, v31
    v_lshl_add_u32 v28, v29, 3, v28
    v_mul_u32_u24 v28, 1152, v28
    s_waitcnt lgkmcnt(4)
    v_mfma_f32_32x32x16_bf16 v[96:111], v[224:227], v[228:231], v[96:111]
    s_waitcnt lgkmcnt(0)
    s_barrier
    v_add_u32 v162, 32768, v162
    v_add_u32 v163, 32768, v163
    v_add_u32 v164, 32768, v164
    v_add_u32 v165, 32768, v165
    v_add_u32 v166, 32768, v166
    v_add_u32 v167, 32768, v167
    v_add_u32 v168, 32768, v168
    v_add_u32 v169, 32768, v169
    ds_read_b128 v[192:195], v162 offset:0
    ds_read_b128 v[196:199], v166 offset:0
    v_lshl_add_u32 v189, v3, 4, v28
    v_mfma_f32_32x32x16_bf16 v[112:127], v[224:227], v[232:235], v[112:127]
    ds_read_b128 v[200:203], v166 offset:4096
    ds_read_b128 v[204:207], v166 offset:8192
    v_mfma_f32_32x32x16_bf16 v[128:143], v[224:227], v[236:239], v[128:143]
    v_mfma_f32_32x32x16_bf16 v[96:111], v[240:243], v[244:247], v[96:111]
    ds_read_b128 v[208:211], v163 offset:0
    ds_read_b128 v[212:215], v167 offset:0
    v_mfma_f32_32x32x16_bf16 v[112:127], v[240:243], v[248:251], v[112:127]
    ds_read_b128 v[216:219], v167 offset:4096
    ds_read_b128 v[220:223], v167 offset:8192
    v_mfma_f32_32x32x16_bf16 v[128:143], v[240:243], v[252:255], v[128:143]
    s_waitcnt lgkmcnt(4)
    v_mfma_f32_32x32x16_bf16 v[96:111], v[192:195], v[196:199], v[96:111]
    ds_read_b128 v[224:227], v164 offset:0
    ds_read_b128 v[228:231], v168 offset:0
    s_mul_i32 s62, s57, 36832
    s_sub_u32 s16, s16, s62
    s_lshl_b32 s62, s57, 4
    v_lshlrev_b32 v179, 3, v3
    v_mfma_f32_32x32x16_bf16 v[112:127], v[192:195], v[200:203], v[112:127]
    ds_read_b128 v[232:235], v168 offset:4096
    ds_read_b128 v[236:239], v168 offset:8192
    v_add_u32 v179, s62, v179
    v_sub_u32 v179, v2, v179
    s_lshl_b32 s50, s40, 16
    s_add_u32 s50, s50, s47
    v_mfma_f32_32x32x16_bf16 v[128:143], v[192:195], v[204:207], v[128:143]
    s_add_u32 s50, s50, 7077888
    s_lshr_b32 s51, s40, 2
    s_lshl_b32 s51, s51, 15
    s_add_u32 s51, s51, s47
    s_waitcnt lgkmcnt(4)
    v_mfma_f32_32x32x16_bf16 v[96:111], v[208:211], v[212:215], v[96:111]
    ds_read_b128 v[240:243], v165 offset:0
    ds_read_b128 v[244:247], v169 offset:0
    s_lshl_b32 s62, s45, 2
    s_add_u32 s51, s51, s62
    s_add_u32 s51, s51, 9175040
    s_cmp_eq_u32 s45, 3
    v_mfma_f32_32x32x16_bf16 v[112:127], v[208:211], v[216:219], v[112:127]
    ds_read_b128 v[248:251], v169 offset:4096
    ds_read_b128 v[252:255], v169 offset:8192
    s_cselect_b32 s4, 0, -1
    s_cmp_eq_u32 s45, 0
    s_cselect_b32 s5, 0, -1
    s_cmp_eq_u32 s45, 1
    v_mfma_f32_32x32x16_bf16 v[128:143], v[208:211], v[220:223], v[128:143]
    s_cselect_b32 s6, 0, -1
    s_mov_b32 s7, -1
    s_cmp_eq_u32 s45, 2
    s_mov_b32 s8, -1
    s_waitcnt lgkmcnt(4)
    v_mfma_f32_32x32x16_bf16 v[96:111], v[224:227], v[228:231], v[96:111]
    s_waitcnt lgkmcnt(0)
    s_barrier
    v_add_u32 v162, 32768, v162
    v_add_u32 v163, 32768, v163
    v_add_u32 v164, 32768, v164
    v_add_u32 v165, 32768, v165
    v_add_u32 v166, 32768, v166
    v_add_u32 v167, 32768, v167
    v_add_u32 v168, 32768, v168
    v_add_u32 v169, 32768, v169
    ds_read_b128 v[192:195], v162 offset:0
    ds_read_b128 v[196:199], v166 offset:0
    s_cselect_b32 s9, 0, -1
    v_mfma_f32_32x32x16_bf16 v[112:127], v[224:227], v[232:235], v[112:127]
    ds_read_b128 v[200:203], v166 offset:4096
    ds_read_b128 v[204:207], v166 offset:8192
    v_mfma_f32_32x32x16_bf16 v[128:143], v[224:227], v[236:239], v[128:143]
    v_mfma_f32_32x32x16_bf16 v[96:111], v[240:243], v[244:247], v[96:111]
    ds_read_b128 v[208:211], v163 offset:0
    ds_read_b128 v[212:215], v167 offset:0
    v_mfma_f32_32x32x16_bf16 v[112:127], v[240:243], v[248:251], v[112:127]
    ds_read_b128 v[216:219], v167 offset:4096
    ds_read_b128 v[220:223], v167 offset:8192
    v_mfma_f32_32x32x16_bf16 v[128:143], v[240:243], v[252:255], v[128:143]
    s_waitcnt lgkmcnt(4)
    v_mfma_f32_32x32x16_bf16 v[96:111], v[192:195], v[196:199], v[96:111]
    ds_read_b128 v[224:227], v164 offset:0
    ds_read_b128 v[228:231], v168 offset:0
    s_waitcnt vmcnt(0)
    v_and_b32 v175, 1, v179
    v_lshlrev_b32 v175, 4, v175
    v_lshrrev_b32 v179, 1, v179
    v_mfma_f32_32x32x16_bf16 v[112:127], v[192:195], v[200:203], v[112:127]
    ds_read_b128 v[232:235], v168 offset:4096
    ds_read_b128 v[236:239], v168 offset:8192
    v_lshlrev_b32 v176, v175, v176
    v_lshlrev_b32 v177, v175, v177
    v_lshlrev_b32 v178, v175, v178
    v_cmp_eq_u32 vcc, 0, v179
    v_mfma_f32_32x32x16_bf16 v[128:143], v[192:195], v[204:207], v[128:143]
    s_nop 1
    v_cndmask_b32 v16, 0, v176, vcc
    v_cndmask_b32 v20, 0, v177, vcc
    v_cndmask_b32 v28, 0, v178, vcc
    s_waitcnt lgkmcnt(4)
    v_mfma_f32_32x32x16_bf16 v[96:111], v[208:211], v[212:215], v[96:111]
    ds_read_b128 v[240:243], v165 offset:0
    ds_read_b128 v[244:247], v169 offset:0
    v_cmp_eq_u32 vcc, 1, v179
    s_nop 1
    v_cndmask_b32 v17, 0, v176, vcc
    v_cndmask_b32 v21, 0, v177, vcc
    v_mfma_f32_32x32x16_bf16 v[112:127], v[208:211], v[216:219], v[112:127]
    ds_read_b128 v[248:251], v169 offset:4096
    ds_read_b128 v[252:255], v169 offset:8192
    v_cndmask_b32 v29, 0, v178, vcc
    v_cmp_eq_u32 vcc, 2, v179
    s_nop 1
    v_cndmask_b32 v18, 0, v176, vcc
    v_mfma_f32_32x32x16_bf16 v[128:143], v[208:211], v[220:223], v[128:143]
    v_cndmask_b32 v22, 0, v177, vcc
    v_cndmask_b32 v30, 0, v178, vcc
    v_cmp_eq_u32 vcc, 3, v179
    s_nop 1
    s_waitcnt lgkmcnt(4)
    v_mfma_f32_32x32x16_bf16 v[96:111], v[224:227], v[228:231], v[96:111]
    s_waitcnt lgkmcnt(0)
    s_barrier
    v_add_u32 v162, 32768, v162
    v_add_u32 v163, 32768, v163
    v_add_u32 v164, 32768, v164
    v_add_u32 v165, 32768, v165
    v_add_u32 v166, 32768, v166
    v_add_u32 v167, 32768, v167
    v_add_u32 v168, 32768, v168
    v_add_u32 v169, 32768, v169
    ds_read_b128 v[192:195], v162 offset:0
    ds_read_b128 v[196:199], v166 offset:0
    v_cndmask_b32 v19, 0, v176, vcc
    v_cndmask_b32 v23, 0, v177, vcc
    v_cndmask_b32 v31, 0, v178, vcc
    buffer_load_dwordx4 v[144:147], v13, s[36:39], s48 offen sc1
    v_mfma_f32_32x32x16_bf16 v[112:127], v[224:227], v[232:235], v[112:127]
    ds_read_b128 v[200:203], v166 offset:4096
    ds_read_b128 v[204:207], v166 offset:8192
    buffer_load_dwordx4 v[148:151], v13, s[36:39], s48 offen offset:512 sc1
    buffer_load_dwordx2 v[152:153], v10, s[36:39], s49 offen sc1
    v_mfma_f32_32x32x16_bf16 v[128:143], v[224:227], v[236:239], v[128:143]
    v_mfma_f32_32x32x16_bf16 v[96:111], v[240:243], v[244:247], v[96:111]
    ds_read_b128 v[208:211], v163 offset:0
    ds_read_b128 v[212:215], v167 offset:0
    v_mfma_f32_32x32x16_bf16 v[112:127], v[240:243], v[248:251], v[112:127]
    ds_read_b128 v[216:219], v167 offset:4096
    ds_read_b128 v[220:223], v167 offset:8192
    v_mfma_f32_32x32x16_bf16 v[128:143], v[240:243], v[252:255], v[128:143]
    s_waitcnt lgkmcnt(4)
    v_mfma_f32_32x32x16_bf16 v[96:111], v[192:195], v[196:199], v[96:111]
    ds_read_b128 v[224:227], v164 offset:0
    ds_read_b128 v[228:231], v168 offset:0
    v_mfma_f32_32x32x16_bf16 v[112:127], v[192:195], v[200:203], v[112:127]
    ds_read_b128 v[232:235], v168 offset:4096
    ds_read_b128 v[236:239], v168 offset:8192
    v_mfma_f32_32x32x16_bf16 v[128:143], v[192:195], v[204:207], v[128:143]
    s_waitcnt lgkmcnt(4)
    v_mfma_f32_32x32x16_bf16 v[96:111], v[208:211], v[212:215], v[96:111]
    ds_read_b128 v[240:243], v165 offset:0
    ds_read_b128 v[244:247], v169 offset:0
    v_mfma_f32_32x32x16_bf16 v[112:127], v[208:211], v[216:219], v[112:127]
    ds_read_b128 v[248:251], v169 offset:4096
    ds_read_b128 v[252:255], v169 offset:8192
    v_mfma_f32_32x32x16_bf16 v[128:143], v[208:211], v[220:223], v[128:143]
    s_waitcnt lgkmcnt(4)
    v_mfma_f32_32x32x16_bf16 v[96:111], v[224:227], v[228:231], v[96:111]
    v_mfma_f32_32x32x16_bf16 v[112:127], v[224:227], v[232:235], v[112:127]
    v_mfma_f32_32x32x16_bf16 v[128:143], v[224:227], v[236:239], v[128:143]
    s_waitcnt lgkmcnt(0)
    s_barrier
    v_mfma_f32_32x32x16_bf16 v[96:111], v[240:243], v[244:247], v[96:111]
    v_mfma_f32_32x32x16_bf16 v[112:127], v[240:243], v[248:251], v[112:127]
    v_mfma_f32_32x32x16_bf16 v[128:143], v[240:243], v[252:255], v[128:143]
    s_load_dword s94, s[30:31], 0
    s_add_u32 s21, s20, 9216
    s_waitcnt vmcnt(0)
    v_and_b32 v152, s4, v152
    v_and_b32 v153, s5, v153
    v_cndmask_b32 v144, 0, v144, s[6:7]
    v_cndmask_b32 v148, 0, v148, s[6:7]
    v_cndmask_b32 v147, 0, v147, s[8:9]
    v_cndmask_b32 v151, 0, v151, s[8:9]
    s_nop 3
    v_cvt_pk_bf16_f32 v208, v96, v97
    v_cvt_pk_bf16_f32 v209, v98, v99
    v_cvt_pk_bf16_f32 v210, v100, v101
    v_cvt_pk_bf16_f32 v211, v102, v103
    v_cvt_pk_bf16_f32 v212, v104, v105
    v_cvt_pk_bf16_f32 v213, v106, v107
    v_cvt_pk_bf16_f32 v214, v108, v109
    v_cvt_pk_bf16_f32 v215, v110, v111
    v_cvt_pk_bf16_f32 v216, v112, v113
    v_cvt_pk_bf16_f32 v217, v114, v115
    v_cvt_pk_bf16_f32 v218, v116, v117
    v_cvt_pk_bf16_f32 v219, v118, v119
    v_cvt_pk_bf16_f32 v220, v120, v121
    v_cvt_pk_bf16_f32 v221, v122, v123
    v_cvt_pk_bf16_f32 v222, v124, v125
    v_cvt_pk_bf16_f32 v223, v126, v127
    v_cvt_pk_bf16_f32 v224, v128, v129
    v_cvt_pk_bf16_f32 v225, v130, v131
    v_cvt_pk_bf16_f32 v226, v132, v133
    v_cvt_pk_bf16_f32 v227, v134, v135
    v_cvt_pk_bf16_f32 v228, v136, v137
    v_cvt_pk_bf16_f32 v229, v138, v139
    v_cvt_pk_bf16_f32 v230, v140, v141
    v_cvt_pk_bf16_f32 v231, v142, v143
    v_mov_b64 v[140:141], 0
    v_mov_b64 v[142:143], 0
    s_nop 1
    v_mfma_f32_32x32x16_bf16 v[96:111], v[140:143], v[140:143], 0
    v_mfma_f32_32x32x16_bf16 v[112:127], v[140:143], v[140:143], 0
    s_mov_b32 s52, s10
    s_mov_b32 s53, s11
    s_mov_b32 s54, 2359296
    s_mov_b32 s55, 0x00020000
    buffer_load_dwordx4 v[192:195], v189, s[52:55], s16 offen offset:0
    buffer_load_dwordx4 v[196:199], v189, s[52:55], s16 offen offset:64
    buffer_load_dwordx4 v[200:203], v189, s[52:55], s16 offen offset:128
    s_waitcnt lgkmcnt(0)
    s_cmp_lg_u32 s94, 0
    s_cbranch_scc1 L_nond_40
    s_mov_b32 s68, 0x40000
    v_mov_b32 v26, 0
L_non_39:
    global_load_dword v24, v26, s[30:31] sc1
    s_waitcnt vmcnt(0)
    v_readfirstlane_b32 s94, v24
    s_sub_u32 s68, s68, 1
    s_cmp_eq_u32 s68, 0
    s_cbranch_scc1 L_nond_40
    s_sleep 4
    s_cmp_eq_u32 s94, 0
    s_cbranch_scc1 L_non_39
L_nond_40:
    s_mov_b32 s60, 0
    s_setprio 2
    s_nop 0
    s_barrier
    ds_read_b128 v[156:159], v10 offset:0
    ds_read_b128 v[164:167], v11 offset:0
    ds_read_b128 v[160:163], v10 offset:1024
    ds_read_b128 v[168:171], v12 offset:0
    ds_read_b128 v[172:175], v12 offset:608
    s_waitcnt lgkmcnt(3)
    v_mfma_f32_32x32x16_bf16 v[32:47], v[156:159], v[144:147], 0
    v_mfma_f32_32x32x16_bf16 v[48:63], v[156:159], v[148:151], 0
    s_nop 9
    v_mfma_f32_32x32x4_2b_bf16 v[32:63], v[164:165], v[152:153], v[32:63]
    s_nop 15
    s_nop 3
.p2align 6
L_at_loop:
    v_exp_f32 v32, v32
    v_exp_f32 v33, v33
    v_exp_f32 v34, v34
    v_exp_f32 v35, v35
    v_cvt_pk_bf16_f32 v128, v32, v33
    v_cvt_pk_bf16_f32 v129, v34, v35
    v_mfma_f32_32x32x16_bf16 v[112:127], v[180:183], v[140:143], v[112:127]
    s_waitcnt lgkmcnt(0)
    v_exp_f32 v36, v36
    v_exp_f32 v37, v37
    v_exp_f32 v38, v38
    v_exp_f32 v39, v39
    v_cvt_pk_bf16_f32 v130, v36, v37
    v_cvt_pk_bf16_f32 v131, v38, v39
    v_mfma_f32_32x32x16_bf16 v[64:79], v[160:163], v[144:147], 0
    ds_read_b128 v[176:179], v12 offset:1216
    v_exp_f32 v40, v40
    v_exp_f32 v41, v41
    v_exp_f32 v42, v42
    v_exp_f32 v43, v43
    v_cvt_pk_bf16_f32 v132, v40, v41
    v_cvt_pk_bf16_f32 v133, v42, v43
    v_mfma_f32_32x32x16_bf16 v[80:95], v[160:163], v[148:151], 0
    ds_read_b128 v[180:183], v12 offset:1824
    v_exp_f32 v44, v44
    v_exp_f32 v45, v45
    v_exp_f32 v46, v46
    v_exp_f32 v47, v47
    v_cvt_pk_bf16_f32 v134, v44, v45
    v_cvt_pk_bf16_f32 v135, v46, v47
    v_mfma_f32_32x32x16_bf16 v[96:111], v[168:171], v[128:131], v[96:111]
    ds_read_b128 v[156:159], v10 offset:2048
    v_exp_f32 v48, v48
    v_exp_f32 v49, v49
    v_exp_f32 v50, v50
    v_exp_f32 v51, v51
    v_cvt_pk_bf16_f32 v136, v48, v49
    v_cvt_pk_bf16_f32 v137, v50, v51
    v_mfma_f32_32x32x4_2b_bf16 v[64:95], v[166:167], v[152:153], v[64:95]
    v_exp_f32 v52, v52
    v_exp_f32 v53, v53
    v_exp_f32 v54, v54
    v_exp_f32 v55, v55
    v_cvt_pk_bf16_f32 v138, v52, v53
    v_cvt_pk_bf16_f32 v139, v54, v55
    v_exp_f32 v56, v56
    v_exp_f32 v57, v57
    v_exp_f32 v58, v58
    v_exp_f32 v59, v59
    v_cvt_pk_bf16_f32 v140, v56, v57
    v_cvt_pk_bf16_f32 v141, v58, v59
    v_mfma_f32_32x32x16_bf16 v[96:111], v[172:175], v[132:135], v[96:111]
    ds_read_b128 v[204:207], v11 offset:512
    v_exp_f32 v60, v60
    v_exp_f32 v61, v61
    v_exp_f32 v62, v62
    v_exp_f32 v63, v63
    v_cvt_pk_bf16_f32 v142, v60, v61
    v_cvt_pk_bf16_f32 v143, v62, v63
    v_mfma_f32_32x32x16_bf16 v[112:127], v[168:171], v[136:139], v[112:127]
    s_cmp_eq_u32 s60, 1
    v_exp_f32 v64, v64
    v_exp_f32 v65, v65
    v_exp_f32 v66, v66
    v_exp_f32 v67, v67
    v_cvt_pk_bf16_f32 v128, v64, v65
    v_cvt_pk_bf16_f32 v129, v66, v67
    v_mfma_f32_32x32x16_bf16 v[112:127], v[172:175], v[140:143], v[112:127]
    s_waitcnt lgkmcnt(0)
    v_exp_f32 v68, v68
    v_exp_f32 v69, v69
    v_exp_f32 v70, v70
    v_exp_f32 v71, v71
    v_cvt_pk_bf16_f32 v130, v68, v69
    v_cvt_pk_bf16_f32 v131, v70, v71
    v_mfma_f32_32x32x16_bf16 v[32:47], v[156:159], v[144:147], 0
    ds_read_b128 v[168:171], v12 offset:2432
    v_exp_f32 v72, v72
    v_exp_f32 v73, v73
    v_exp_f32 v74, v74
    v_exp_f32 v75, v75
    v_cvt_pk_bf16_f32 v132, v72, v73
    v_cvt_pk_bf16_f32 v133, v74, v75
    v_mfma_f32_32x32x16_bf16 v[48:63], v[156:159], v[148:151], 0
    ds_read_b128 v[172:175], v12 offset:3040
    v_exp_f32 v76, v76
    v_exp_f32 v77, v77
    v_exp_f32 v78, v78
    v_exp_f32 v79, v79
    v_cvt_pk_bf16_f32 v134, v76, v77
    v_cvt_pk_bf16_f32 v135, v78, v79
    v_mfma_f32_32x32x16_bf16 v[96:111], v[176:179], v[128:131], v[96:111]
    ds_read_b128 v[160:163], v10 offset:3072
    v_exp_f32 v80, v80
    v_exp_f32 v81, v81
    v_exp_f32 v82, v82
    v_exp_f32 v83, v83
    v_cvt_pk_bf16_f32 v136, v80, v81
    v_cvt_pk_bf16_f32 v137, v82, v83
    v_mfma_f32_32x32x4_2b_bf16 v[32:63], v[204:205], v[152:153], v[32:63]
    v_exp_f32 v84, v84
    v_exp_f32 v85, v85
    v_exp_f32 v86, v86
    v_exp_f32 v87, v87
    v_cvt_pk_bf16_f32 v138, v84, v85
    v_cvt_pk_bf16_f32 v139, v86, v87
    v_exp_f32 v88, v88
    v_exp_f32 v89, v89
    v_exp_f32 v90, v90
    v_exp_f32 v91, v91
    v_cvt_pk_bf16_f32 v140, v88, v89
    v_cvt_pk_bf16_f32 v141, v90, v91
    v_mfma_f32_32x32x16_bf16 v[96:111], v[180:183], v[132:135], v[96:111]
    v_exp_f32 v92, v92
    v_exp_f32 v93, v93
    v_exp_f32 v94, v94
    v_exp_f32 v95, v95
    v_cvt_pk_bf16_f32 v142, v92, v93
    v_cvt_pk_bf16_f32 v143, v94, v95
    v_mfma_f32_32x32x16_bf16 v[112:127], v[176:179], v[136:139], v[112:127]
    s_cbranch_scc1 L_at_ev2
L_at_r2:
    v_exp_f32 v32, v32
    v_exp_f32 v33, v33
    v_exp_f32 v34, v34
    v_exp_f32 v35, v35
    v_cvt_pk_bf16_f32 v128, v32, v33
    v_cvt_pk_bf16_f32 v129, v34, v35
    v_mfma_f32_32x32x16_bf16 v[112:127], v[180:183], v[140:143], v[112:127]
    s_waitcnt lgkmcnt(0)
    v_exp_f32 v36, v36
    v_exp_f32 v37, v37
    v_exp_f32 v38, v38
    v_exp_f32 v39, v39
    v_cvt_pk_bf16_f32 v130, v36, v37
    v_cvt_pk_bf16_f32 v131, v38, v39
    v_mfma_f32_32x32x16_bf16 v[64:79], v[160:163], v[144:147], 0
    ds_read_b128 v[176:179], v12 offset:3648
    v_exp_f32 v40, v40
    v_exp_f32 v41, v41
    v_exp_f32 v42, v42
    v_exp_f32 v43, v43
    v_cvt_pk_bf16_f32 v132, v40, v41
    v_cvt_pk_bf16_f32 v133, v42, v43
    v_mfma_f32_32x32x16_bf16 v[80:95], v[160:163], v[148:151], 0
    ds_read_b128 v[180:183], v12 offset:4256
    v_exp_f32 v44, v44
    v_exp_f32 v45, v45
    v_exp_f32 v46, v46
    v_exp_f32 v47, v47
    v_cvt_pk_bf16_f32 v134, v44, v45
    v_cvt_pk_bf16_f32 v135, v46, v47
    v_mfma_f32_32x32x16_bf16 v[96:111], v[168:171], v[128:131], v[96:111]
    ds_read_b128 v[156:159], v10 offset:4096
    v_exp_f32 v48, v48
    v_exp_f32 v49, v49
    v_exp_f32 v50, v50
    v_exp_f32 v51, v51
    v_cvt_pk_bf16_f32 v136, v48, v49
    v_cvt_pk_bf16_f32 v137, v50, v51
    v_mfma_f32_32x32x4_2b_bf16 v[64:95], v[206:207], v[152:153], v[64:95]
    v_exp_f32 v52, v52
    v_exp_f32 v53, v53
    v_exp_f32 v54, v54
    v_exp_f32 v55, v55
    v_cvt_pk_bf16_f32 v138, v52, v53
    v_cvt_pk_bf16_f32 v139, v54, v55
    v_exp_f32 v56, v56
    v_exp_f32 v57, v57
    v_exp_f32 v58, v58
    v_exp_f32 v59, v59
    v_cvt_pk_bf16_f32 v140, v56, v57
    v_cvt_pk_bf16_f32 v141, v58, v59
    v_mfma_f32_32x32x16_bf16 v[96:111], v[172:175], v[132:135], v[96:111]
    ds_read_b128 v[164:167], v11 offset:1024
    v_exp_f32 v60, v60
    v_exp_f32 v61, v61
    v_exp_f32 v62, v62
    v_exp_f32 v63, v63
    v_cvt_pk_bf16_f32 v142, v60, v61
    v_cvt_pk_bf16_f32 v143, v62, v63
    v_mfma_f32_32x32x16_bf16 v[112:127], v[168:171], v[136:139], v[112:127]
    ds_write_b32 v191, v10
    v_exp_f32 v64, v64
    v_exp_f32 v65, v65
    v_exp_f32 v66, v66
    v_exp_f32 v67, v67
    v_cvt_pk_bf16_f32 v128, v64, v65
    v_cvt_pk_bf16_f32 v129, v66, v67
    v_mfma_f32_32x32x16_bf16 v[112:127], v[172:175], v[140:143], v[112:127]
    s_waitcnt lgkmcnt(0)
    v_exp_f32 v68, v68
    v_exp_f32 v69, v69
    v_exp_f32 v70, v70
    v_exp_f32 v71, v71
    v_cvt_pk_bf16_f32 v130, v68, v69
    v_cvt_pk_bf16_f32 v131, v70, v71
    v_mfma_f32_32x32x16_bf16 v[32:47], v[156:159], v[144:147], 0
    ds_read_b128 v[168:171], v12 offset:4864
    v_exp_f32 v72, v72
    v_exp_f32 v73, v73
    v_exp_f32 v74, v74
    v_exp_f32 v75, v75
    v_cvt_pk_bf16_f32 v132, v72, v73
    v_cvt_pk_bf16_f32 v133, v74, v75
    v_mfma_f32_32x32x16_bf16 v[48:63], v[156:159], v[148:151], 0
    ds_read_b128 v[172:175], v12 offset:5472
    v_exp_f32 v76, v76
    v_exp_f32 v77, v77
    v_exp_f32 v78, v78
    v_exp_f32 v79, v79
    v_cvt_pk_bf16_f32 v134, v76, v77
    v_cvt_pk_bf16_f32 v135, v78, v79
    v_mfma_f32_32x32x16_bf16 v[96:111], v[176:179], v[128:131], v[96:111]
    ds_read_b128 v[160:163], v10 offset:5120
    v_exp_f32 v80, v80
    v_exp_f32 v81, v81
    v_exp_f32 v82, v82
    v_exp_f32 v83, v83
    v_cvt_pk_bf16_f32 v136, v80, v81
    v_cvt_pk_bf16_f32 v137, v82, v83
    v_mfma_f32_32x32x4_2b_bf16 v[32:63], v[164:165], v[152:153], v[32:63]
    v_exp_f32 v84, v84
    v_exp_f32 v85, v85
    v_exp_f32 v86, v86
    v_exp_f32 v87, v87
    v_cvt_pk_bf16_f32 v138, v84, v85
    v_cvt_pk_bf16_f32 v139, v86, v87
    v_exp_f32 v88, v88
    v_exp_f32 v89, v89
    v_exp_f32 v90, v90
    v_exp_f32 v91, v91
    v_cvt_pk_bf16_f32 v140, v88, v89
    v_cvt_pk_bf16_f32 v141, v90, v91
    v_mfma_f32_32x32x16_bf16 v[96:111], v[180:183], v[132:135], v[96:111]
    v_exp_f32 v92, v92
    v_exp_f32 v93, v93
    v_exp_f32 v94, v94
    v_exp_f32 v95, v95
    v_cvt_pk_bf16_f32 v142, v92, v93
    v_cvt_pk_bf16_f32 v143, v94, v95
    v_mfma_f32_32x32x16_bf16 v[112:127], v[176:179], v[136:139], v[112:127]
    v_exp_f32 v32, v32
    v_exp_f32 v33, v33
    v_exp_f32 v34, v34
    v_exp_f32 v35, v35
    v_cvt_pk_bf16_f32 v128, v32, v33
    v_cvt_pk_bf16_f32 v129, v34, v35
    v_mfma_f32_32x32x16_bf16 v[112:127], v[180:183], v[140:143], v[112:127]
    s_waitcnt lgkmcnt(0)
    v_exp_f32 v36, v36
    v_exp_f32 v37, v37
    v_exp_f32 v38, v38
    v_exp_f32 v39, v39
    v_cvt_pk_bf16_f32 v130, v36, v37
    v_cvt_pk_bf16_f32 v131, v38, v39
    v_mfma_f32_32x32x16_bf16 v[64:79], v[160:163], v[144:147], 0
    ds_read_b128 v[176:179], v12 offset:6080
    v_exp_f32 v40, v40
    v_exp_f32 v41, v41
    v_exp_f32 v42, v42
    v_exp_f32 v43, v43
    v_cvt_pk_bf16_f32 v132, v40, v41
    v_cvt_pk_bf16_f32 v133, v42, v43
    v_mfma_f32_32x32x16_bf16 v[80:95], v[160:163], v[148:151], 0
    ds_read_b128 v[180:183], v12 offset:6688
    v_exp_f32 v44, v44
    v_exp_f32 v45, v45
    v_exp_f32 v46, v46
    v_exp_f32 v47, v47
    v_cvt_pk_bf16_f32 v134, v44, v45
    v_cvt_pk_bf16_f32 v135, v46, v47
    v_mfma_f32_32x32x16_bf16 v[96:111], v[168:171], v[128:131], v[96:111]
    ds_read_b128 v[156:159], v10 offset:6144
    v_exp_f32 v48, v48
    v_exp_f32 v49, v49
    v_exp_f32 v50, v50
    v_exp_f32 v51, v51
    v_cvt_pk_bf16_f32 v136, v48, v49
    v_cvt_pk_bf16_f32 v137, v50, v51
    v_mfma_f32_32x32x4_2b_bf16 v[64:95], v[166:167], v[152:153], v[64:95]
    v_exp_f32 v52, v52
    v_exp_f32 v53, v53
    v_exp_f32 v54, v54
    v_exp_f32 v55, v55
    v_cvt_pk_bf16_f32 v138, v52, v53
    v_cvt_pk_bf16_f32 v139, v54, v55
    v_exp_f32 v56, v56
    v_exp_f32 v57, v57
    v_exp_f32 v58, v58
    v_exp_f32 v59, v59
    v_cvt_pk_bf16_f32 v140, v56, v57
    v_cvt_pk_bf16_f32 v141, v58, v59
    v_mfma_f32_32x32x16_bf16 v[96:111], v[172:175], v[132:135], v[96:111]
    ds_read_b128 v[204:207], v11 offset:1536
    v_exp_f32 v60, v60
    v_exp_f32 v61, v61
    v_exp_f32 v62, v62
    v_exp_f32 v63, v63
    v_cvt_pk_bf16_f32 v142, v60, v61
    v_cvt_pk_bf16_f32 v143, v62, v63
    v_mfma_f32_32x32x16_bf16 v[112:127], v[168:171], v[136:139], v[112:127]
    s_cmp_eq_u32 s60, 1
    v_exp_f32 v64, v64
    v_exp_f32 v65, v65
    v_exp_f32 v66, v66
    v_exp_f32 v67, v67
    v_cvt_pk_bf16_f32 v128, v64, v65
    v_cvt_pk_bf16_f32 v129, v66, v67
    v_mfma_f32_32x32x16_bf16 v[112:127], v[172:175], v[140:143], v[112:127]
    s_waitcnt lgkmcnt(0)
    v_exp_f32 v68, v68
    v_exp_f32 v69, v69
    v_exp_f32 v70, v70
    v_exp_f32 v71, v71
    v_cvt_pk_bf16_f32 v130, v68, v69
    v_cvt_pk_bf16_f32 v131, v70, v71
    v_mfma_f32_32x32x16_bf16 v[32:47], v[156:159], v[144:147], 0
    ds_read_b128 v[168:171], v12 offset:7296
    v_exp_f32 v72, v72
    v_exp_f32 v73, v73
    v_exp_f32 v74, v74
    v_exp_f32 v75, v75
    v_cvt_pk_bf16_f32 v132, v72, v73
    v_cvt_pk_bf16_f32 v133, v74, v75
    v_mfma_f32_32x32x16_bf16 v[48:63], v[156:159], v[148:151], 0
    ds_read_b128 v[172:175], v12 offset:7904
    v_exp_f32 v76, v76
    v_exp_f32 v77, v77
    v_exp_f32 v78, v78
    v_exp_f32 v79, v79
    v_cvt_pk_bf16_f32 v134, v76, v77
    v_cvt_pk_bf16_f32 v135, v78, v79
    v_mfma_f32_32x32x16_bf16 v[96:111], v[176:179], v[128:131], v[96:111]
    ds_read_b128 v[160:163], v10 offset:7168
    v_exp_f32 v80, v80
    v_exp_f32 v81, v81
    v_exp_f32 v82, v82
    v_exp_f32 v83, v83
    v_cvt_pk_bf16_f32 v136, v80, v81
    v_cvt_pk_bf16_f32 v137, v82, v83
    v_mfma_f32_32x32x4_2b_bf16 v[32:63], v[204:205], v[152:153], v[32:63]
    v_exp_f32 v84, v84
    v_exp_f32 v85, v85
    v_exp_f32 v86, v86
    v_exp_f32 v87, v87
    v_cvt_pk_bf16_f32 v138, v84, v85
    v_cvt_pk_bf16_f32 v139, v86, v87
    v_exp_f32 v88, v88
    v_exp_f32 v89, v89
    v_exp_f32 v90, v90
    v_exp_f32 v91, v91
    v_cvt_pk_bf16_f32 v140, v88, v89
    v_cvt_pk_bf16_f32 v141, v90, v91
    v_mfma_f32_32x32x16_bf16 v[96:111], v[180:183], v[132:135], v[96:111]
    v_exp_f32 v92, v92
    v_exp_f32 v93, v93
    v_exp_f32 v94, v94
    v_exp_f32 v95, v95
    v_cvt_pk_bf16_f32 v142, v92, v93
    v_cvt_pk_bf16_f32 v143, v94, v95
    v_mfma_f32_32x32x16_bf16 v[112:127], v[176:179], v[136:139], v[112:127]
    s_cbranch_scc1 L_at_evt
L_at_nobar:
    v_exp_f32 v32, v32
    v_exp_f32 v33, v33
    v_exp_f32 v34, v34
    v_exp_f32 v35, v35
    v_cvt_pk_bf16_f32 v128, v32, v33
    v_cvt_pk_bf16_f32 v129, v34, v35
    v_mfma_f32_32x32x16_bf16 v[112:127], v[180:183], v[140:143], v[112:127]
    s_waitcnt lgkmcnt(0)
    v_exp_f32 v36, v36
    v_exp_f32 v37, v37
    v_exp_f32 v38, v38
    v_exp_f32 v39, v39
    v_cvt_pk_bf16_f32 v130, v36, v37
    v_cvt_pk_bf16_f32 v131, v38, v39
    v_mfma_f32_32x32x16_bf16 v[64:79], v[160:163], v[144:147], 0
    ds_read_b128 v[176:179], v12 offset:8512
    v_exp_f32 v40, v40
    v_exp_f32 v41, v41
    v_exp_f32 v42, v42
    v_exp_f32 v43, v43
    v_cvt_pk_bf16_f32 v132, v40, v41
    v_cvt_pk_bf16_f32 v133, v42, v43
    v_mfma_f32_32x32x16_bf16 v[80:95], v[160:163], v[148:151], 0
    ds_read_b128 v[180:183], v12 offset:9120
    v_exp_f32 v44, v44
    v_exp_f32 v45, v45
    v_exp_f32 v46, v46
    v_exp_f32 v47, v47
    v_cvt_pk_bf16_f32 v134, v44, v45
    v_cvt_pk_bf16_f32 v135, v46, v47
    v_mfma_f32_32x32x16_bf16 v[96:111], v[168:171], v[128:131], v[96:111]
    ds_read_b128 v[156:159], v10 offset:20480
    v_exp_f32 v48, v48
    v_exp_f32 v49, v49
    v_exp_f32 v50, v50
    v_exp_f32 v51, v51
    v_cvt_pk_bf16_f32 v136, v48, v49
    v_cvt_pk_bf16_f32 v137, v50, v51
    v_mfma_f32_32x32x4_2b_bf16 v[64:95], v[206:207], v[152:153], v[64:95]
    v_exp_f32 v52, v52
    v_exp_f32 v53, v53
    v_exp_f32 v54, v54
    v_exp_f32 v55, v55
    v_cvt_pk_bf16_f32 v138, v52, v53
    v_cvt_pk_bf16_f32 v139, v54, v55
    v_exp_f32 v56, v56
    v_exp_f32 v57, v57
    v_exp_f32 v58, v58
    v_exp_f32 v59, v59
    v_cvt_pk_bf16_f32 v140, v56, v57
    v_cvt_pk_bf16_f32 v141, v58, v59
    v_mfma_f32_32x32x16_bf16 v[96:111], v[172:175], v[132:135], v[96:111]
    ds_read_b128 v[164:167], v11 offset:20480
    v_exp_f32 v60, v60
    v_exp_f32 v61, v61
    v_exp_f32 v62, v62
    v_exp_f32 v63, v63
    v_cvt_pk_bf16_f32 v142, v60, v61
    v_cvt_pk_bf16_f32 v143, v62, v63
    v_mfma_f32_32x32x16_bf16 v[112:127], v[168:171], v[136:139], v[112:127]
    s_add_u32 s60, s60, 1
    v_exp_f32 v64, v64
    v_exp_f32 v65, v65
    v_exp_f32 v66, v66
    v_exp_f32 v67, v67
    v_cvt_pk_bf16_f32 v128, v64, v65
    v_cvt_pk_bf16_f32 v129, v66, v67
    v_mfma_f32_32x32x16_bf16 v[112:127], v[172:175], v[140:143], v[112:127]
    s_waitcnt lgkmcnt(0)
    v_exp_f32 v68, v68
    v_exp_f32 v69, v69
    v_exp_f32 v70, v70
    v_exp_f32 v71, v71
    v_cvt_pk_bf16_f32 v130, v68, v69
    v_cvt_pk_bf16_f32 v131, v70, v71
    v_mfma_f32_32x32x16_bf16 v[32:47], v[156:159], v[144:147], 0
    ds_read_b128 v[168:171], v12 offset:20480
    v_exp_f32 v72, v72
    v_exp_f32 v73, v73
    v_exp_f32 v74, v74
    v_exp_f32 v75, v75
    v_cvt_pk_bf16_f32 v132, v72, v73
    v_cvt_pk_bf16_f32 v133, v74, v75
    v_mfma_f32_32x32x16_bf16 v[48:63], v[156:159], v[148:151], 0
    ds_read_b128 v[172:175], v12 offset:21088
    v_exp_f32 v76, v76
    v_exp_f32 v77, v77
    v_exp_f32 v78, v78
    v_exp_f32 v79, v79
    v_cvt_pk_bf16_f32 v134, v76, v77
    v_cvt_pk_bf16_f32 v135, v78, v79
    v_mfma_f32_32x32x16_bf16 v[96:111], v[176:179], v[128:131], v[96:111]
    ds_read_b128 v[160:163], v10 offset:21504
    v_exp_f32 v80, v80
    v_exp_f32 v81, v81
    v_exp_f32 v82, v82
    v_exp_f32 v83, v83
    v_cvt_pk_bf16_f32 v136, v80, v81
    v_cvt_pk_bf16_f32 v137, v82, v83
    v_mfma_f32_32x32x4_2b_bf16 v[32:63], v[164:165], v[152:153], v[32:63]
    v_exp_f32 v84, v84
    v_exp_f32 v85, v85
    v_exp_f32 v86, v86
    v_exp_f32 v87, v87
    v_cvt_pk_bf16_f32 v138, v84, v85
    v_cvt_pk_bf16_f32 v139, v86, v87
    v_exp_f32 v88, v88
    v_exp_f32 v89, v89
    v_exp_f32 v90, v90
    v_exp_f32 v91, v91
    v_cvt_pk_bf16_f32 v140, v88, v89
    v_cvt_pk_bf16_f32 v141, v90, v91
    v_mfma_f32_32x32x16_bf16 v[96:111], v[180:183], v[132:135], v[96:111]
    v_exp_f32 v92, v92
    v_exp_f32 v93, v93
    v_exp_f32 v94, v94
    v_exp_f32 v95, v95
    v_cvt_pk_bf16_f32 v142, v92, v93
    v_cvt_pk_bf16_f32 v143, v94, v95
    v_mfma_f32_32x32x16_bf16 v[112:127], v[176:179], v[136:139], v[112:127]
    s_cmp_lt_u32 s60, 8
    v_add_u32 v10, 20480, v10
    v_add_u32 v11, 20480, v11
    v_add_u32 v12, 20480, v12
    s_cbranch_scc1 L_at_loop
    v_mfma_f32_32x32x16_bf16 v[112:127], v[180:183], v[140:143], v[112:127]
    ds_write_b32 v191, v10
    s_mov_b32 s61, 0
L_at_fin:
    s_nop 15
    s_nop 3
    v_cmp_eq_u32 vcc, 0, v3
    s_nop 1
    v_cndmask_b32 v80, v108, v106, vcc
    v_cndmask_b32 v81, v124, v122, vcc
    s_cmp_lg_u32 s61, 0
    s_cbranch_scc1 L_at_store
    v_min_f32 v82, v80, v81
    v_add_f32 v84, v80, v81
    v_mov_b32 v83, v84
    v_add_f32 v83, abs(v96), v83
    v_add_f32 v83, abs(v97), v83
    v_add_f32 v83, abs(v98), v83
    v_add_f32 v83, abs(v99), v83
    v_add_f32 v83, abs(v100), v83
    v_add_f32 v83, abs(v101), v83
    v_add_f32 v83, abs(v102), v83
    v_add_f32 v83, abs(v103), v83
    v_add_f32 v83, abs(v104), v83
    v_add_f32 v83, abs(v105), v83
    v_add_f32 v83, abs(v112), v83
    v_add_f32 v83, abs(v113), v83
    v_add_f32 v83, abs(v114), v83
    v_add_f32 v83, abs(v115), v83
    v_add_f32 v83, abs(v116), v83
    v_add_f32 v83, abs(v117), v83
    v_add_f32 v83, abs(v118), v83
    v_add_f32 v83, abs(v119), v83
    v_add_f32 v83, abs(v120), v83
    v_add_f32 v83, abs(v121), v83
    v_cmp_le_f32 vcc, 0x21800000, v82
    s_mov_b64 s[62:63], vcc
    v_cmp_ge_f32 vcc, 0x5d800000, v84
    s_and_b64 s[62:63], s[62:63], vcc
    v_cmp_ge_f32 vcc, 0x7b800000, v83
    s_and_b64 s[62:63], s[62:63], vcc
    s_cmp_eq_u64 s[62:63], exec
    s_cbranch_scc0 L_at_slow
L_at_store:
    v_rcp_f32 v80, v80
    s_nop 0
    v_mul_f32 v96, v96, v80
    v_mul_f32 v97, v97, v80
    v_mul_f32 v98, v98, v80
    v_mul_f32 v99, v99, v80
    v_mul_f32 v100, v100, v80
    v_mul_f32 v101, v101, v80
    v_mul_f32 v102, v102, v80
    v_mul_f32 v103, v103, v80
    v_mul_f32 v104, v104, v80
    v_mul_f32 v105, v105, v80
    v_cvt_pk_bf16_f32 v128, v96, v97
    v_cvt_pk_bf16_f32 v129, v98, v99
    v_cvt_pk_bf16_f32 v130, v100, v101
    v_cvt_pk_bf16_f32 v131, v102, v103
    v_cvt_pk_bf16_f32 v132, v104, v105
    buffer_store_dwordx4 v[128:131], v13, s[36:39], s50 offen offset:0 sc1
    buffer_store_dword v132, v14, s[36:39], s51 offen offset:0 sc1
    v_rcp_f32 v81, v81
    s_nop 0
    v_mul_f32 v112, v112, v81
    v_mul_f32 v113, v113, v81
    v_mul_f32 v114, v114, v81
    v_mul_f32 v115, v115, v81
    v_mul_f32 v116, v116, v81
    v_mul_f32 v117, v117, v81
    v_mul_f32 v118, v118, v81
    v_mul_f32 v119, v119, v81
    v_mul_f32 v120, v120, v81
    v_mul_f32 v121, v121, v81
    v_cvt_pk_bf16_f32 v136, v112, v113
    v_cvt_pk_bf16_f32 v137, v114, v115
    v_cvt_pk_bf16_f32 v138, v116, v117
    v_cvt_pk_bf16_f32 v139, v118, v119
    v_cvt_pk_bf16_f32 v140, v120, v121
    buffer_store_dwordx4 v[136:139], v13, s[36:39], s50 offen offset:512 sc1
    buffer_store_dword v140, v14, s[36:39], s51 offen offset:512 sc1
    s_setprio 1
    s_branch L_c_p3
L_at_e1l:
    v_mov_b32 v24, 163712
    ds_read_b128 v[24:27], v24
    s_waitcnt lgkmcnt(0)
L_at_evt:
    v_and_b32 v24, v24, v25
    v_and_b32 v26, v26, v27
    v_and_b32 v24, v24, v26
    s_nop 0
    v_readfirstlane_b32 s62, v24
    s_cmp_eq_u32 s62, 0
    s_cbranch_scc1 L_at_e1l
    s_waitcnt vmcnt(0)
    s_mov_b64 exec, 1
    v_mov_b32 v24, 163728
    v_mov_b32 v25, 1
    ds_add_u32 v24, v25
    s_mov_b64 exec, -1
    s_branch L_at_nobar
L_at_ev2:
    buffer_store_dwordx4 v[208:211], v190, s[36:39], s20 offen offset:0 sc1
    buffer_store_dwordx4 v[212:215], v190, s[36:39], s21 offen offset:0 sc1
    buffer_store_dwordx4 v[216:219], v190, s[36:39], s20 offen offset:512 sc1
    buffer_store_dwordx4 v[220:223], v190, s[36:39], s21 offen offset:512 sc1
    buffer_store_dwordx4 v[224:227], v190, s[36:39], s20 offen offset:1024 sc1
    buffer_store_dwordx4 v[228:231], v190, s[36:39], s21 offen offset:1024 sc1
    v_mov_b32 v24, 163712
    ds_read_b128 v[24:27], v24
    s_branch L_at_r2
L_at_slow:
    v_lshlrev_b32 v85, 4, v2
    v_lshlrev_b32 v86, 4, v3
    v_lshl_add_u32 v86, v2, 5, v86
    v_cmp_gt_u32 vcc, 18, v2
    v_mov_b32 v87, 1073741824
    v_mov_b32 v88, 0x3f803f80
    v_cndmask_b32 v86, v87, v86, vcc
    v_cndmask_b32 v88, v88, 0, vcc
    s_lshl_b32 s62, s43, 15
    s_add_u32 s62, s62, 2359296
    s_add_u32 s63, s44, 2359296
    s_mul_i32 s64, s40, 576
    s_add_u32 s64, s64, 4718592
    s_mov_b32 s60, 0
    v_mov_b32 v82, 0xff800000
    v_mov_b32 v83, 0xff800000
L_at_slowa:
    buffer_load_dwordx4 v[156:159], v13, s[36:39], s62 offen sc1
    buffer_load_dwordx2 v[164:165], v85, s[36:39], s63 offen sc1
    s_waitcnt vmcnt(0)
    v_mfma_f32_32x32x16_bf16 v[32:47], v[156:159], v[144:147], 0
    v_mfma_f32_32x32x16_bf16 v[48:63], v[156:159], v[148:151], 0
    s_nop 9
    v_mfma_f32_32x32x4_2b_bf16 v[32:63], v[164:165], v[152:153], v[32:63]
    s_nop 15
    s_nop 3
    v_max3_f32 v82, v32, v33, v82
    v_max3_f32 v82, v34, v35, v82
    v_max3_f32 v82, v36, v37, v82
    v_max3_f32 v82, v38, v39, v82
    v_max3_f32 v82, v40, v41, v82
    v_max3_f32 v82, v42, v43, v82
    v_max3_f32 v82, v44, v45, v82
    v_max3_f32 v82, v46, v47, v82
    v_max3_f32 v83, v48, v49, v83
    v_max3_f32 v83, v50, v51, v83
    v_max3_f32 v83, v52, v53, v83
    v_max3_f32 v83, v54, v55, v83
    v_max3_f32 v83, v56, v57, v83
    v_max3_f32 v83, v58, v59, v83
    v_max3_f32 v83, v60, v61, v83
    v_max3_f32 v83, v62, v63, v83
    s_add_u32 s62, s62, 512
    s_add_u32 s63, s63, 512
    s_add_u32 s64, s64, 36864
    s_add_u32 s60, s60, 1
    s_cmp_lt_u32 s60, 64
    s_cbranch_scc1 L_at_slowa
    v_xor_b32 v84, 32, v1
    v_lshlrev_b32 v84, 2, v84
    ds_bpermute_b32 v80, v84, v82
    ds_bpermute_b32 v81, v84, v83
    s_waitcnt lgkmcnt(0)
    v_max_f32 v82, v82, v80
    v_max_f32 v83, v83, v81
    s_lshl_b32 s62, s43, 15
    s_add_u32 s62, s62, 2359296
    s_add_u32 s63, s44, 2359296
    s_mul_i32 s64, s40, 576
    s_add_u32 s64, s64, 4718592
    s_mov_b32 s60, 0
    v_mov_b32 v96, 0
    v_mov_b32 v97, 0
    v_mov_b32 v98, 0
    v_mov_b32 v99, 0
    v_mov_b32 v100, 0
    v_mov_b32 v101, 0
    v_mov_b32 v102, 0
    v_mov_b32 v103, 0
    v_mov_b32 v104, 0
    v_mov_b32 v105, 0
    v_mov_b32 v106, 0
    v_mov_b32 v107, 0
    v_mov_b32 v108, 0
    v_mov_b32 v109, 0
    v_mov_b32 v110, 0
    v_mov_b32 v111, 0
    v_mov_b32 v112, 0
    v_mov_b32 v113, 0
    v_mov_b32 v114, 0
    v_mov_b32 v115, 0
    v_mov_b32 v116, 0
    v_mov_b32 v117, 0
    v_mov_b32 v118, 0
    v_mov_b32 v119, 0
    v_mov_b32 v120, 0
    v_mov_b32 v121, 0
    v_mov_b32 v122, 0
    v_mov_b32 v123, 0
    v_mov_b32 v124, 0
    v_mov_b32 v125, 0
    v_mov_b32 v126, 0
    v_mov_b32 v127, 0
L_at_slowb:
    buffer_load_dwordx4 v[168:171], v86, s[36:39], s64 offen sc1
    s_add_u32 s65, s64, 18432
    buffer_load_dwordx4 v[172:175], v86, s[36:39], s65 offen sc1
    buffer_load_dwordx4 v[156:159], v13, s[36:39], s62 offen sc1
    buffer_load_dwordx2 v[164:165], v85, s[36:39], s63 offen sc1
    s_waitcnt vmcnt(0)
    v_mfma_f32_32x32x16_bf16 v[32:47], v[156:159], v[144:147], 0
    v_mfma_f32_32x32x16_bf16 v[48:63], v[156:159], v[148:151], 0
    s_nop 9
    v_mfma_f32_32x32x4_2b_bf16 v[32:63], v[164:165], v[152:153], v[32:63]
    s_nop 15
    s_nop 3
    v_or_b32 v168, v168, v88
    v_or_b32 v169, v169, v88
    v_or_b32 v170, v170, v88
    v_or_b32 v171, v171, v88
    v_or_b32 v172, v172, v88
    v_or_b32 v173, v173, v88
    v_or_b32 v174, v174, v88
    v_or_b32 v175, v175, v88
    v_sub_f32 v32, v32, v82
    v_sub_f32 v33, v33, v82
    v_sub_f32 v34, v34, v82
    v_sub_f32 v35, v35, v82
    v_sub_f32 v36, v36, v82
    v_sub_f32 v37, v37, v82
    v_sub_f32 v38, v38, v82
    v_sub_f32 v39, v39, v82
    v_sub_f32 v40, v40, v82
    v_sub_f32 v41, v41, v82
    v_sub_f32 v42, v42, v82
    v_sub_f32 v43, v43, v82
    v_sub_f32 v44, v44, v82
    v_sub_f32 v45, v45, v82
    v_sub_f32 v46, v46, v82
    v_sub_f32 v47, v47, v82
    v_sub_f32 v48, v48, v83
    v_sub_f32 v49, v49, v83
    v_sub_f32 v50, v50, v83
    v_sub_f32 v51, v51, v83
    v_sub_f32 v52, v52, v83
    v_sub_f32 v53, v53, v83
    v_sub_f32 v54, v54, v83
    v_sub_f32 v55, v55, v83
    v_sub_f32 v56, v56, v83
    v_sub_f32 v57, v57, v83
    v_sub_f32 v58, v58, v83
    v_sub_f32 v59, v59, v83
    v_sub_f32 v60, v60, v83
    v_sub_f32 v61, v61, v83
    v_sub_f32 v62, v62, v83
    v_sub_f32 v63, v63, v83
    v_exp_f32 v32, v32
    v_exp_f32 v33, v33
    v_exp_f32 v34, v34
    v_exp_f32 v35, v35
    v_cvt_pk_bf16_f32 v128, v32, v33
    v_cvt_pk_bf16_f32 v129, v34, v35
    v_exp_f32 v36, v36
    v_exp_f32 v37, v37
    v_exp_f32 v38, v38
    v_exp_f32 v39, v39
    v_cvt_pk_bf16_f32 v130, v36, v37
    v_cvt_pk_bf16_f32 v131, v38, v39
    v_exp_f32 v40, v40
    v_exp_f32 v41, v41
    v_exp_f32 v42, v42
    v_exp_f32 v43, v43
    v_cvt_pk_bf16_f32 v132, v40, v41
    v_cvt_pk_bf16_f32 v133, v42, v43
    v_exp_f32 v44, v44
    v_exp_f32 v45, v45
    v_exp_f32 v46, v46
    v_exp_f32 v47, v47
    v_cvt_pk_bf16_f32 v134, v44, v45
    v_cvt_pk_bf16_f32 v135, v46, v47
    v_exp_f32 v48, v48
    v_exp_f32 v49, v49
    v_exp_f32 v50, v50
    v_exp_f32 v51, v51
    v_cvt_pk_bf16_f32 v136, v48, v49
    v_cvt_pk_bf16_f32 v137, v50, v51
    v_exp_f32 v52, v52
    v_exp_f32 v53, v53
    v_exp_f32 v54, v54
    v_exp_f32 v55, v55
    v_cvt_pk_bf16_f32 v138, v52, v53
    v_cvt_pk_bf16_f32 v139, v54, v55
    v_exp_f32 v56, v56
    v_exp_f32 v57, v57
    v_exp_f32 v58, v58
    v_exp_f32 v59, v59
    v_cvt_pk_bf16_f32 v140, v56, v57
    v_cvt_pk_bf16_f32 v141, v58, v59
    v_exp_f32 v60, v60
    v_exp_f32 v61, v61
    v_exp_f32 v62, v62
    v_exp_f32 v63, v63
    v_cvt_pk_bf16_f32 v142, v60, v61
    v_cvt_pk_bf16_f32 v143, v62, v63
    s_nop 1
    v_mfma_f32_32x32x16_bf16 v[96:111], v[168:171], v[128:131], v[96:111]
    v_mfma_f32_32x32x16_bf16 v[96:111], v[172:175], v[132:135], v[96:111]
    v_mfma_f32_32x32x16_bf16 v[112:127], v[168:171], v[136:139], v[112:127]
    v_mfma_f32_32x32x16_bf16 v[112:127], v[172:175], v[140:143], v[112:127]
    s_nop 7
    s_add_u32 s62, s62, 512
    s_add_u32 s63, s63, 512
    s_add_u32 s64, s64, 36864
    s_add_u32 s60, s60, 1
    s_cmp_lt_u32 s60, 64
    s_cbranch_scc1 L_at_slowb
    s_mov_b32 s61, 1
    s_branch L_at_fin
L_c_p3:
    s_cmp_ge_u32 s35, 24
    s_cbranch_scc0 L_c_p3go
    s_waitcnt vmcnt(0)
    v_lshlrev_b32 v26, 7, v1
    v_mov_b32 v27, s94
    s_mov_b32 exec_lo, 0x1
    s_mov_b32 exec_hi, 0x0
    buffer_store_dword v27, v26, s[36:39], s14 offen sc1
    s_mov_b64 exec, -1
    s_endpgm
L_c_p3go:
    v_mfma_f32_32x32x16_bf16 v[208:223], v[192:195], v[16:19], 0
    v_mfma_f32_32x32x16_bf16 v[224:239], v[196:199], v[20:23], 0
    v_mfma_f32_32x32x16_bf16 v[240:255], v[200:203], v[28:31], 0
    s_barrier
    s_mov_b32 s40, s28
    s_mov_b32 s41, s29
    s_mov_b32 s42, 9437184
    s_mov_b32 s43, 0x00020000
    ds_read_b64_tr_b16 v[32:33], v188 offset:0
    ds_read_b64_tr_b16 v[34:35], v188 offset:512
    ds_read_b128 v[36:39], v184 offset:0
    ds_read_b128 v[40:43], v184 offset:4096
    ds_read_b128 v[44:47], v184 offset:8192
    ds_read_b64_tr_b16 v[48:49], v188 offset:2048
    ds_read_b64_tr_b16 v[50:51], v188 offset:2560
    ds_read_b128 v[52:55], v185 offset:0
    ds_read_b128 v[56:59], v185 offset:4096
    ds_read_b128 v[60:63], v185 offset:8192
    ds_read_b64_tr_b16 v[64:65], v188 offset:4096
    ds_read_b64_tr_b16 v[66:67], v188 offset:4608
    ds_read_b128 v[68:71], v186 offset:0
    ds_read_b128 v[72:75], v186 offset:4096
    ds_read_b128 v[76:79], v186 offset:8192
    ds_read_b64_tr_b16 v[80:81], v188 offset:6144
    ds_read_b64_tr_b16 v[82:83], v188 offset:6656
    ds_read_b128 v[84:87], v187 offset:0
    ds_read_b128 v[88:91], v187 offset:4096
    ds_read_b128 v[92:95], v187 offset:8192
    s_waitcnt lgkmcnt(15)
    v_mfma_f32_32x32x16_bf16 v[208:223], v[32:35], v[36:39], v[208:223]
    s_waitcnt lgkmcnt(15)
    v_mfma_f32_32x32x16_bf16 v[224:239], v[32:35], v[40:43], v[224:239]
    s_waitcnt lgkmcnt(15)
    v_mfma_f32_32x32x16_bf16 v[240:255], v[32:35], v[44:47], v[240:255]
    s_waitcnt lgkmcnt(12)
    v_mfma_f32_32x32x16_bf16 v[208:223], v[48:51], v[52:55], v[208:223]
    s_waitcnt lgkmcnt(11)
    v_mfma_f32_32x32x16_bf16 v[224:239], v[48:51], v[56:59], v[224:239]
    s_waitcnt lgkmcnt(10)
    v_mfma_f32_32x32x16_bf16 v[240:255], v[48:51], v[60:63], v[240:255]
    s_waitcnt vmcnt(0)
    v_lshlrev_b32 v26, 7, v1
    v_mov_b32 v27, s94
    s_mov_b32 exec_lo, 0x1
    s_mov_b32 exec_hi, 0x0
    buffer_store_dword v27, v26, s[36:39], s14 offen sc1
    s_mov_b64 exec, -1
    s_waitcnt lgkmcnt(0)
    s_barrier
    v_add_u32 v184, 40960, v184
    v_add_u32 v185, 40960, v185
    v_add_u32 v186, 40960, v186
    v_add_u32 v187, 40960, v187
    v_add_u32 v188, 40960, v188
    ds_read_b64_tr_b16 v[96:97], v188 offset:0
    ds_read_b64_tr_b16 v[98:99], v188 offset:512
    ds_read_b128 v[100:103], v184 offset:0
    ds_read_b128 v[104:107], v184 offset:4096
    v_mfma_f32_32x32x16_bf16 v[208:223], v[64:67], v[68:71], v[208:223]
    ds_read_b128 v[108:111], v184 offset:8192
    ds_read_b64_tr_b16 v[112:113], v188 offset:2048
    ds_read_b64_tr_b16 v[114:115], v188 offset:2560
    ds_read_b128 v[116:119], v185 offset:0
    v_mfma_f32_32x32x16_bf16 v[224:239], v[64:67], v[72:75], v[224:239]
    ds_read_b128 v[120:123], v185 offset:4096
    ds_read_b128 v[124:127], v185 offset:8192
    ds_read_b64_tr_b16 v[128:129], v188 offset:4096
    ds_read_b64_tr_b16 v[130:131], v188 offset:4608
    v_mfma_f32_32x32x16_bf16 v[240:255], v[64:67], v[76:79], v[240:255]
    ds_read_b128 v[132:135], v186 offset:0
    ds_read_b128 v[136:139], v186 offset:4096
    ds_read_b128 v[140:143], v186 offset:8192
    ds_read_b64_tr_b16 v[144:145], v188 offset:6144
    v_mfma_f32_32x32x16_bf16 v[208:223], v[80:83], v[84:87], v[208:223]
    ds_read_b64_tr_b16 v[146:147], v188 offset:6656
    ds_read_b128 v[148:151], v187 offset:0
    ds_read_b128 v[152:155], v187 offset:4096
    ds_read_b128 v[156:159], v187 offset:8192
    v_mfma_f32_32x32x16_bf16 v[224:239], v[80:83], v[88:91], v[224:239]
    v_mfma_f32_32x32x16_bf16 v[240:255], v[80:83], v[92:95], v[240:255]
    s_waitcnt lgkmcnt(15)
    v_mfma_f32_32x32x16_bf16 v[208:223], v[96:99], v[100:103], v[208:223]
    s_waitcnt lgkmcnt(15)
    v_mfma_f32_32x32x16_bf16 v[224:239], v[96:99], v[104:107], v[224:239]
    s_waitcnt lgkmcnt(0)
    s_barrier
    v_add_u32 v184, 40960, v184
    v_add_u32 v185, 40960, v185
    v_add_u32 v186, 40960, v186
    v_add_u32 v187, 40960, v187
    v_add_u32 v188, 40960, v188
    ds_read_b64_tr_b16 v[32:33], v188 offset:0
    ds_read_b64_tr_b16 v[34:35], v188 offset:512
    ds_read_b128 v[36:39], v184 offset:0
    v_mfma_f32_32x32x16_bf16 v[240:255], v[96:99], v[108:111], v[240:255]
    ds_read_b128 v[40:43], v184 offset:4096
    ds_read_b128 v[44:47], v184 offset:8192
    ds_read_b64_tr_b16 v[48:49], v188 offset:2048
    v_mfma_f32_32x32x16_bf16 v[208:223], v[112:115], v[116:119], v[208:223]
    ds_read_b64_tr_b16 v[50:51], v188 offset:2560
    ds_read_b128 v[52:55], v185 offset:0
    ds_read_b128 v[56:59], v185 offset:4096
    v_mfma_f32_32x32x16_bf16 v[224:239], v[112:115], v[120:123], v[224:239]
    ds_read_b128 v[60:63], v185 offset:8192
    ds_read_b64_tr_b16 v[64:65], v188 offset:4096
    ds_read_b64_tr_b16 v[66:67], v188 offset:4608
    v_mfma_f32_32x32x16_bf16 v[240:255], v[112:115], v[124:127], v[240:255]
    ds_read_b128 v[68:71], v186 offset:0
    ds_read_b128 v[72:75], v186 offset:4096
    ds_read_b128 v[76:79], v186 offset:8192
    v_mfma_f32_32x32x16_bf16 v[208:223], v[128:131], v[132:135], v[208:223]
    ds_read_b64_tr_b16 v[80:81], v188 offset:6144
    ds_read_b64_tr_b16 v[82:83], v188 offset:6656
    ds_read_b128 v[84:87], v187 offset:0
    v_mfma_f32_32x32x16_bf16 v[224:239], v[128:131], v[136:139], v[224:239]
    ds_read_b128 v[88:91], v187 offset:4096
    ds_read_b128 v[92:95], v187 offset:8192
    v_mfma_f32_32x32x16_bf16 v[240:255], v[128:131], v[140:143], v[240:255]
    v_mfma_f32_32x32x16_bf16 v[208:223], v[144:147], v[148:151], v[208:223]
    v_mfma_f32_32x32x16_bf16 v[224:239], v[144:147], v[152:155], v[224:239]
    v_mfma_f32_32x32x16_bf16 v[240:255], v[144:147], v[156:159], v[240:255]
    s_waitcnt lgkmcnt(15)
    v_mfma_f32_32x32x16_bf16 v[208:223], v[32:35], v[36:39], v[208:223]
    s_waitcnt lgkmcnt(15)
    v_mfma_f32_32x32x16_bf16 v[224:239], v[32:35], v[40:43], v[224:239]
    s_waitcnt lgkmcnt(0)
    s_barrier
    v_add_u32 v184, 40960, v184
    v_add_u32 v185, 40960, v185
    v_add_u32 v186, 40960, v186
    v_add_u32 v187, 40960, v187
    v_add_u32 v188, 40960, v188
    ds_read_b64_tr_b16 v[96:97], v188 offset:0
    ds_read_b64_tr_b16 v[98:99], v188 offset:512
    ds_read_b128 v[100:103], v184 offset:0
    v_mfma_f32_32x32x16_bf16 v[240:255], v[32:35], v[44:47], v[240:255]
    ds_read_b128 v[104:107], v184 offset:4096
    ds_read_b128 v[108:111], v184 offset:8192
    ds_read_b64_tr_b16 v[112:113], v188 offset:2048
    v_mfma_f32_32x32x16_bf16 v[208:223], v[48:51], v[52:55], v[208:223]
    ds_read_b64_tr_b16 v[114:115], v188 offset:2560
    ds_read_b128 v[116:119], v185 offset:0
    ds_read_b128 v[120:123], v185 offset:4096
    v_mfma_f32_32x32x16_bf16 v[224:239], v[48:51], v[56:59], v[224:239]
    ds_read_b128 v[124:127], v185 offset:8192
    ds_read_b64_tr_b16 v[128:129], v188 offset:4096
    ds_read_b64_tr_b16 v[130:131], v188 offset:4608
    v_mfma_f32_32x32x16_bf16 v[240:255], v[48:51], v[60:63], v[240:255]
    ds_read_b128 v[132:135], v186 offset:0
    ds_read_b128 v[136:139], v186 offset:4096
    ds_read_b128 v[140:143], v186 offset:8192
    v_mfma_f32_32x32x16_bf16 v[208:223], v[64:67], v[68:71], v[208:223]
    ds_read_b64_tr_b16 v[144:145], v188 offset:6144
    ds_read_b64_tr_b16 v[146:147], v188 offset:6656
    ds_read_b128 v[148:151], v187 offset:0
    v_mfma_f32_32x32x16_bf16 v[224:239], v[64:67], v[72:75], v[224:239]
    ds_read_b128 v[152:155], v187 offset:4096
    ds_read_b128 v[156:159], v187 offset:8192
    v_mfma_f32_32x32x16_bf16 v[240:255], v[64:67], v[76:79], v[240:255]
    v_mfma_f32_32x32x16_bf16 v[208:223], v[80:83], v[84:87], v[208:223]
    v_mfma_f32_32x32x16_bf16 v[224:239], v[80:83], v[88:91], v[224:239]
    v_mfma_f32_32x32x16_bf16 v[240:255], v[80:83], v[92:95], v[240:255]
    s_waitcnt lgkmcnt(15)
    v_mfma_f32_32x32x16_bf16 v[208:223], v[96:99], v[100:103], v[208:223]
    s_waitcnt lgkmcnt(15)
    v_mfma_f32_32x32x16_bf16 v[224:239], v[96:99], v[104:107], v[224:239]
    s_waitcnt lgkmcnt(0)
    s_barrier
    v_add_u32 v184, 4294844416, v184
    v_add_u32 v185, 4294844416, v185
    v_add_u32 v186, 4294844416, v186
    v_add_u32 v187, 4294844416, v187
    v_add_u32 v188, 4294844416, v188
    ds_read_b64_tr_b16 v[32:33], v188 offset:0
    ds_read_b64_tr_b16 v[34:35], v188 offset:512
    ds_read_b128 v[36:39], v184 offset:0
    v_mfma_f32_32x32x16_bf16 v[240:255], v[96:99], v[108:111], v[240:255]
    ds_read_b128 v[40:43], v184 offset:4096
    ds_read_b128 v[44:47], v184 offset:8192
    ds_read_b64_tr_b16 v[48:49], v188 offset:2048
    v_mfma_f32_32x32x16_bf16 v[208:223], v[112:115], v[116:119], v[208:223]
    ds_read_b64_tr_b16 v[50:51], v188 offset:2560
    ds_read_b128 v[52:55], v185 offset:0
    ds_read_b128 v[56:59], v185 offset:4096
    v_mfma_f32_32x32x16_bf16 v[224:239], v[112:115], v[120:123], v[224:239]
    ds_read_b128 v[60:63], v185 offset:8192
    ds_read_b64_tr_b16 v[64:65], v188 offset:4096
    ds_read_b64_tr_b16 v[66:67], v188 offset:4608
    v_mfma_f32_32x32x16_bf16 v[240:255], v[112:115], v[124:127], v[240:255]
    ds_read_b128 v[68:71], v186 offset:0
    ds_read_b128 v[72:75], v186 offset:4096
    ds_read_b128 v[76:79], v186 offset:8192
    v_mfma_f32_32x32x16_bf16 v[208:223], v[128:131], v[132:135], v[208:223]
    ds_read_b64_tr_b16 v[80:81], v188 offset:6144
    ds_read_b64_tr_b16 v[82:83], v188 offset:6656
    ds_read_b128 v[84:87], v187 offset:0
    v_mfma_f32_32x32x16_bf16 v[224:239], v[128:131], v[136:139], v[224:239]
    ds_read_b128 v[88:91], v187 offset:4096
    ds_read_b128 v[92:95], v187 offset:8192
    v_mfma_f32_32x32x16_bf16 v[240:255], v[128:131], v[140:143], v[240:255]
    v_mfma_f32_32x32x16_bf16 v[208:223], v[144:147], v[148:151], v[208:223]
    v_mfma_f32_32x32x16_bf16 v[224:239], v[144:147], v[152:155], v[224:239]
    v_mfma_f32_32x32x16_bf16 v[240:255], v[144:147], v[156:159], v[240:255]
    s_waitcnt lgkmcnt(15)
    v_mfma_f32_32x32x16_bf16 v[208:223], v[32:35], v[36:39], v[208:223]
    s_waitcnt lgkmcnt(15)
    v_mfma_f32_32x32x16_bf16 v[224:239], v[32:35], v[40:43], v[224:239]
    s_waitcnt lgkmcnt(0)
    s_barrier
    v_add_u32 v184, 40960, v184
    v_add_u32 v185, 40960, v185
    v_add_u32 v186, 40960, v186
    v_add_u32 v187, 40960, v187
    v_add_u32 v188, 40960, v188
    ds_read_b64_tr_b16 v[96:97], v188 offset:0
    ds_read_b64_tr_b16 v[98:99], v188 offset:512
    ds_read_b128 v[100:103], v184 offset:0
    v_mfma_f32_32x32x16_bf16 v[240:255], v[32:35], v[44:47], v[240:255]
    ds_read_b128 v[104:107], v184 offset:4096
    ds_read_b128 v[108:111], v184 offset:8192
    ds_read_b64_tr_b16 v[112:113], v188 offset:2048
    v_mfma_f32_32x32x16_bf16 v[208:223], v[48:51], v[52:55], v[208:223]
    ds_read_b64_tr_b16 v[114:115], v188 offset:2560
    ds_read_b128 v[116:119], v185 offset:0
    ds_read_b128 v[120:123], v185 offset:4096
    v_mfma_f32_32x32x16_bf16 v[224:239], v[48:51], v[56:59], v[224:239]
    ds_read_b128 v[124:127], v185 offset:8192
    ds_read_b64_tr_b16 v[128:129], v188 offset:4096
    ds_read_b64_tr_b16 v[130:131], v188 offset:4608
    v_mfma_f32_32x32x16_bf16 v[240:255], v[48:51], v[60:63], v[240:255]
    ds_read_b128 v[132:135], v186 offset:0
    ds_read_b128 v[136:139], v186 offset:4096
    ds_read_b128 v[140:143], v186 offset:8192
    v_mfma_f32_32x32x16_bf16 v[208:223], v[64:67], v[68:71], v[208:223]
    ds_read_b64_tr_b16 v[144:145], v188 offset:6144
    ds_read_b64_tr_b16 v[146:147], v188 offset:6656
    ds_read_b128 v[148:151], v187 offset:0
    v_mfma_f32_32x32x16_bf16 v[224:239], v[64:67], v[72:75], v[224:239]
    ds_read_b128 v[152:155], v187 offset:4096
    ds_read_b128 v[156:159], v187 offset:8192
    v_mfma_f32_32x32x16_bf16 v[240:255], v[64:67], v[76:79], v[240:255]
    v_mfma_f32_32x32x16_bf16 v[208:223], v[80:83], v[84:87], v[208:223]
    v_mfma_f32_32x32x16_bf16 v[224:239], v[80:83], v[88:91], v[224:239]
    v_mfma_f32_32x32x16_bf16 v[240:255], v[80:83], v[92:95], v[240:255]
    s_waitcnt lgkmcnt(15)
    v_mfma_f32_32x32x16_bf16 v[208:223], v[96:99], v[100:103], v[208:223]
    s_waitcnt lgkmcnt(15)
    v_mfma_f32_32x32x16_bf16 v[224:239], v[96:99], v[104:107], v[224:239]
    s_waitcnt lgkmcnt(0)
    s_barrier
    v_add_u32 v184, 40960, v184
    v_add_u32 v185, 40960, v185
    v_add_u32 v186, 40960, v186
    v_add_u32 v187, 40960, v187
    v_add_u32 v188, 40960, v188
    ds_read_b64_tr_b16 v[32:33], v188 offset:0
    ds_read_b64_tr_b16 v[34:35], v188 offset:512
    ds_read_b128 v[36:39], v184 offset:0
    v_mfma_f32_32x32x16_bf16 v[240:255], v[96:99], v[108:111], v[240:255]
    ds_read_b128 v[40:43], v184 offset:4096
    ds_read_b128 v[44:47], v184 offset:8192
    ds_read_b64_tr_b16 v[48:49], v188 offset:2048
    v_mfma_f32_32x32x16_bf16 v[208:223], v[112:115], v[116:119], v[208:223]
    ds_read_b64_tr_b16 v[50:51], v188 offset:2560
    ds_read_b128 v[52:55], v185 offset:0
    ds_read_b128 v[56:59], v185 offset:4096
    v_mfma_f32_32x32x16_bf16 v[224:239], v[112:115], v[120:123], v[224:239]
    ds_read_b128 v[60:63], v185 offset:8192
    ds_read_b64_tr_b16 v[64:65], v188 offset:4096
    ds_read_b64_tr_b16 v[66:67], v188 offset:4608
    v_mfma_f32_32x32x16_bf16 v[240:255], v[112:115], v[124:127], v[240:255]
    ds_read_b128 v[68:71], v186 offset:0
    ds_read_b128 v[72:75], v186 offset:4096
    ds_read_b128 v[76:79], v186 offset:8192
    v_mfma_f32_32x32x16_bf16 v[208:223], v[128:131], v[132:135], v[208:223]
    ds_read_b64_tr_b16 v[80:81], v188 offset:6144
    ds_read_b64_tr_b16 v[82:83], v188 offset:6656
    ds_read_b128 v[84:87], v187 offset:0
    v_mfma_f32_32x32x16_bf16 v[224:239], v[128:131], v[136:139], v[224:239]
    ds_read_b128 v[88:91], v187 offset:4096
    ds_read_b128 v[92:95], v187 offset:8192
    v_mfma_f32_32x32x16_bf16 v[240:255], v[128:131], v[140:143], v[240:255]
    v_mfma_f32_32x32x16_bf16 v[208:223], v[144:147], v[148:151], v[208:223]
    v_mfma_f32_32x32x16_bf16 v[224:239], v[144:147], v[152:155], v[224:239]
    v_mfma_f32_32x32x16_bf16 v[240:255], v[144:147], v[156:159], v[240:255]
    s_waitcnt lgkmcnt(15)
    v_mfma_f32_32x32x16_bf16 v[208:223], v[32:35], v[36:39], v[208:223]
    s_waitcnt lgkmcnt(15)
    v_mfma_f32_32x32x16_bf16 v[224:239], v[32:35], v[40:43], v[224:239]
    s_waitcnt lgkmcnt(0)
    s_barrier
    v_add_u32 v184, 40960, v184
    v_add_u32 v185, 40960, v185
    v_add_u32 v186, 40960, v186
    v_add_u32 v187, 40960, v187
    v_add_u32 v188, 40960, v188
    ds_read_b64_tr_b16 v[96:97], v188 offset:0
    ds_read_b64_tr_b16 v[98:99], v188 offset:512
    ds_read_b128 v[100:103], v184 offset:0
    v_mfma_f32_32x32x16_bf16 v[240:255], v[32:35], v[44:47], v[240:255]
    ds_read_b128 v[104:107], v184 offset:4096
    ds_read_b128 v[108:111], v184 offset:8192
    ds_read_b64_tr_b16 v[112:113], v188 offset:2048
    v_mfma_f32_32x32x16_bf16 v[208:223], v[48:51], v[52:55], v[208:223]
    ds_read_b64_tr_b16 v[114:115], v188 offset:2560
    ds_read_b128 v[116:119], v185 offset:0
    ds_read_b128 v[120:123], v185 offset:4096
    v_mfma_f32_32x32x16_bf16 v[224:239], v[48:51], v[56:59], v[224:239]
    ds_read_b128 v[124:127], v185 offset:8192
    ds_read_b64_tr_b16 v[128:129], v188 offset:4096
    ds_read_b64_tr_b16 v[130:131], v188 offset:4608
    v_mfma_f32_32x32x16_bf16 v[240:255], v[48:51], v[60:63], v[240:255]
    ds_read_b128 v[132:135], v186 offset:0
    ds_read_b128 v[136:139], v186 offset:4096
    ds_read_b128 v[140:143], v186 offset:8192
    v_mfma_f32_32x32x16_bf16 v[208:223], v[64:67], v[68:71], v[208:223]
    ds_read_b64_tr_b16 v[144:145], v188 offset:6144
    ds_read_b64_tr_b16 v[146:147], v188 offset:6656
    ds_read_b128 v[148:151], v187 offset:0
    v_mfma_f32_32x32x16_bf16 v[224:239], v[64:67], v[72:75], v[224:239]
    ds_read_b128 v[152:155], v187 offset:4096
    ds_read_b128 v[156:159], v187 offset:8192
    v_mfma_f32_32x32x16_bf16 v[240:255], v[64:67], v[76:79], v[240:255]
    v_mfma_f32_32x32x16_bf16 v[208:223], v[80:83], v[84:87], v[208:223]
    v_mfma_f32_32x32x16_bf16 v[224:239], v[80:83], v[88:91], v[224:239]
    v_mfma_f32_32x32x16_bf16 v[240:255], v[80:83], v[92:95], v[240:255]
    s_waitcnt lgkmcnt(15)
    v_mfma_f32_32x32x16_bf16 v[208:223], v[96:99], v[100:103], v[208:223]
    s_waitcnt lgkmcnt(15)
    v_mfma_f32_32x32x16_bf16 v[224:239], v[96:99], v[104:107], v[224:239]
    v_add_u32 v184, 4294844416, v184
    v_add_u32 v185, 4294844416, v185
    v_add_u32 v186, 4294844416, v186
    v_add_u32 v187, 4294844416, v187
    v_add_u32 v188, 4294844416, v188
    ds_read_b64_tr_b16 v[32:33], v188 offset:0
    ds_read_b64_tr_b16 v[34:35], v188 offset:512
    ds_read_b128 v[36:39], v184 offset:0
    s_waitcnt lgkmcnt(15)
    v_mfma_f32_32x32x16_bf16 v[240:255], v[96:99], v[108:111], v[240:255]
    ds_read_b128 v[40:43], v184 offset:4096
    ds_read_b128 v[44:47], v184 offset:8192
    ds_read_b64_tr_b16 v[48:49], v188 offset:2048
    s_waitcnt lgkmcnt(15)
    v_mfma_f32_32x32x16_bf16 v[208:223], v[112:115], v[116:119], v[208:223]
    ds_read_b64_tr_b16 v[50:51], v188 offset:2560
    ds_read_b128 v[52:55], v185 offset:0
    ds_read_b128 v[56:59], v185 offset:4096
    s_waitcnt lgkmcnt(15)
    v_mfma_f32_32x32x16_bf16 v[224:239], v[112:115], v[120:123], v[224:239]
    ds_read_b128 v[60:63], v185 offset:8192
    ds_read_b64_tr_b16 v[64:65], v188 offset:4096
    ds_read_b64_tr_b16 v[66:67], v188 offset:4608
    s_waitcnt lgkmcnt(15)
    v_mfma_f32_32x32x16_bf16 v[240:255], v[112:115], v[124:127], v[240:255]
    ds_read_b128 v[68:71], v186 offset:0
    ds_read_b128 v[72:75], v186 offset:4096
    ds_read_b128 v[76:79], v186 offset:8192
    s_waitcnt lgkmcnt(15)
    v_mfma_f32_32x32x16_bf16 v[208:223], v[128:131], v[132:135], v[208:223]
    ds_read_b64_tr_b16 v[80:81], v188 offset:6144
    ds_read_b64_tr_b16 v[82:83], v188 offset:6656
    ds_read_b128 v[84:87], v187 offset:0
    s_waitcnt lgkmcnt(15)
    v_mfma_f32_32x32x16_bf16 v[224:239], v[128:131], v[136:139], v[224:239]
    ds_read_b128 v[88:91], v187 offset:4096
    ds_read_b128 v[92:95], v187 offset:8192
    s_waitcnt lgkmcnt(15)
    v_mfma_f32_32x32x16_bf16 v[240:255], v[128:131], v[140:143], v[240:255]
    s_waitcnt lgkmcnt(15)
    v_mfma_f32_32x32x16_bf16 v[208:223], v[144:147], v[148:151], v[208:223]
    s_waitcnt lgkmcnt(15)
    v_mfma_f32_32x32x16_bf16 v[224:239], v[144:147], v[152:155], v[224:239]
    s_waitcnt lgkmcnt(15)
    v_mfma_f32_32x32x16_bf16 v[240:255], v[144:147], v[156:159], v[240:255]
    s_waitcnt lgkmcnt(15)
    v_mfma_f32_32x32x16_bf16 v[208:223], v[32:35], v[36:39], v[208:223]
    s_waitcnt lgkmcnt(15)
    v_mfma_f32_32x32x16_bf16 v[224:239], v[32:35], v[40:43], v[224:239]
    s_waitcnt lgkmcnt(15)
    v_mfma_f32_32x32x16_bf16 v[240:255], v[32:35], v[44:47], v[240:255]
    s_waitcnt lgkmcnt(12)
    v_mfma_f32_32x32x16_bf16 v[208:223], v[48:51], v[52:55], v[208:223]
    s_waitcnt lgkmcnt(11)
    v_mfma_f32_32x32x16_bf16 v[224:239], v[48:51], v[56:59], v[224:239]
    s_waitcnt lgkmcnt(10)
    v_mfma_f32_32x32x16_bf16 v[240:255], v[48:51], v[60:63], v[240:255]
    s_waitcnt lgkmcnt(7)
    v_mfma_f32_32x32x16_bf16 v[208:223], v[64:67], v[68:71], v[208:223]
    s_waitcnt lgkmcnt(6)
    v_mfma_f32_32x32x16_bf16 v[224:239], v[64:67], v[72:75], v[224:239]
    s_waitcnt lgkmcnt(5)
    v_mfma_f32_32x32x16_bf16 v[240:255], v[64:67], v[76:79], v[240:255]
    s_waitcnt lgkmcnt(2)
    v_mfma_f32_32x32x16_bf16 v[208:223], v[80:83], v[84:87], v[208:223]
    s_waitcnt lgkmcnt(1)
    v_mfma_f32_32x32x16_bf16 v[224:239], v[80:83], v[88:91], v[224:239]
    s_waitcnt lgkmcnt(0)
    v_mfma_f32_32x32x16_bf16 v[240:255], v[80:83], v[92:95], v[240:255]
    s_nop 15
    s_nop 3
    ds_write_b128 v6, v[216:219] offset:40960
    ds_write_b128 v6, v[220:223] offset:41984
    ds_write_b128 v6, v[232:235] offset:43008
    ds_write_b128 v6, v[236:239] offset:44032
    ds_write_b128 v6, v[248:251] offset:45056
    ds_write_b128 v6, v[252:255] offset:46080
    s_lshl_b32 s68, s3, 2
    s_add_u32 s68, s68, 4
    v_mov_b32 v24, s68
    v_mov_b32 v25, s94
    s_waitcnt lgkmcnt(0)
    ds_write_b32 v24, v25 offset:65532
    v_and_b32 v26, 3, v1
    v_lshlrev_b32 v26, 2, v26
    v_add_u32 v26, 65536, v26
    s_mov_b32 s68, 0x400000
L_tw_41:
    ds_read_b32 v27, v26
    s_sub_u32 s68, s68, 1
    s_cbranch_scc1 L_tw_41x
    s_waitcnt lgkmcnt(0)
    v_cmp_eq_u32 vcc, s94, v27
    s_cmp_eq_u64 vcc, exec
    s_cbranch_scc0 L_tw_41
L_tw_41x:
    s_waitcnt lgkmcnt(0)
    ds_read_b128 v[216:219], v7 offset:40960
    ds_read_b128 v[220:223], v7 offset:41984
    ds_read_b128 v[232:235], v7 offset:43008
    ds_read_b128 v[236:239], v7 offset:44032
    ds_read_b128 v[248:251], v7 offset:45056
    ds_read_b128 v[252:255], v7 offset:46080
    s_waitcnt lgkmcnt(5)
    v_pk_add_f32 v[208:209], v[208:209], v[216:217]
    v_pk_add_f32 v[210:211], v[210:211], v[218:219]
    s_waitcnt lgkmcnt(4)
    v_pk_add_f32 v[212:213], v[212:213], v[220:221]
    v_pk_add_f32 v[214:215], v[214:215], v[222:223]
    s_waitcnt lgkmcnt(3)
    v_pk_add_f32 v[224:225], v[224:225], v[232:233]
    v_pk_add_f32 v[226:227], v[226:227], v[234:235]
    s_waitcnt lgkmcnt(2)
    v_pk_add_f32 v[228:229], v[228:229], v[236:237]
    v_pk_add_f32 v[230:231], v[230:231], v[238:239]
    s_waitcnt lgkmcnt(1)
    v_pk_add_f32 v[240:241], v[240:241], v[248:249]
    v_pk_add_f32 v[242:243], v[242:243], v[250:251]
    s_waitcnt lgkmcnt(0)
    v_pk_add_f32 v[244:245], v[244:245], v[252:253]
    v_pk_add_f32 v[246:247], v[246:247], v[254:255]
    s_add_u32 s63, s12, 0
    buffer_store_dword v208, v8, s[40:43], s63 offen offset:0 sc1
    buffer_store_dword v224, v8, s[40:43], s63 offen offset:128 sc1
    buffer_store_dword v240, v8, s[40:43], s63 offen offset:256 sc1
    s_add_u32 s63, s12, 36864
    buffer_store_dword v209, v8, s[40:43], s63 offen offset:0 sc1
    buffer_store_dword v225, v8, s[40:43], s63 offen offset:128 sc1
    buffer_store_dword v241, v8, s[40:43], s63 offen offset:256 sc1
    s_add_u32 s63, s12, 4608
    buffer_store_dword v210, v8, s[40:43], s63 offen offset:0 sc1
    buffer_store_dword v226, v8, s[40:43], s63 offen offset:128 sc1
    buffer_store_dword v242, v8, s[40:43], s63 offen offset:256 sc1
    s_add_u32 s63, s12, 41472
    buffer_store_dword v211, v8, s[40:43], s63 offen offset:0 sc1
    buffer_store_dword v227, v8, s[40:43], s63 offen offset:128 sc1
    buffer_store_dword v243, v8, s[40:43], s63 offen offset:256 sc1
    s_add_u32 s63, s12, 73728
    buffer_store_dword v212, v8, s[40:43], s63 offen offset:0 sc1
    buffer_store_dword v228, v8, s[40:43], s63 offen offset:128 sc1
    buffer_store_dword v244, v8, s[40:43], s63 offen offset:256 sc1
    s_add_u32 s63, s12, 110592
    buffer_store_dword v213, v8, s[40:43], s63 offen offset:0 sc1
    buffer_store_dword v229, v8, s[40:43], s63 offen offset:128 sc1
    buffer_store_dword v245, v8, s[40:43], s63 offen offset:256 sc1
    s_add_u32 s63, s12, 78336
    buffer_store_dword v214, v8, s[40:43], s63 offen offset:0 sc1
    buffer_store_dword v230, v8, s[40:43], s63 offen offset:128 sc1
    buffer_store_dword v246, v8, s[40:43], s63 offen offset:256 sc1
    s_add_u32 s63, s12, 115200
    buffer_store_dword v215, v8, s[40:43], s63 offen offset:0 sc1
    buffer_store_dword v231, v8, s[40:43], s63 offen offset:128 sc1
    buffer_store_dword v247, v8, s[40:43], s63 offen offset:256 sc1
    s_endpgm
L_cut_h:
    s_waitcnt vmcnt(8)
    s_barrier
    s_lshl_b32 s48, s63, s7
    s_add_u32 s48, s48, s60
    s_mul_i32 s49, s63, s62
    s_add_u32 s49, s49, s61
    s_add_u32 s63, s63, 1
    s_cmp_eq_u32 s63, 9
    s_cselect_b32 s63, 0, s63
    s_add_u32 m0, s56, 131072
    s_nop 0
    buffer_load_dwordx4 v10, s[40:43], s48 offen offset:0 lds
    buffer_load_dwordx4 v11, s[40:43], s48 offen offset:1024 lds
    buffer_load_dwordx4 v12, s[40:43], s48 offen offset:2048 lds
    buffer_load_dwordx4 v13, s[40:43], s48 offen offset:3072 lds
    s_add_u32 m0, s57, 131072
    s_nop 0
    buffer_load_dwordx4 v14, s[44:47], s49 offen offset:0 lds
    buffer_load_dwordx4 v15, s[44:47], s49 offen offset:1024 lds
    buffer_load_dwordx4 v16, s[44:47], s49 offen offset:2048 lds
    buffer_load_dwordx4 v17, s[44:47], s49 offen offset:3072 lds
    s_lshl_b32 s48, s63, s7
    s_add_u32 s48, s48, s60
    s_mul_i32 s49, s63, s62
    s_add_u32 s49, s49, s61
    s_add_u32 s63, s63, 1
    s_cmp_eq_u32 s63, 9
    s_cselect_b32 s63, 0, s63
    s_add_u32 m0, s56, 0
    s_nop 0
    buffer_load_dwordx4 v10, s[40:43], s48 offen offset:0 lds
    buffer_load_dwordx4 v11, s[40:43], s48 offen offset:1024 lds
    buffer_load_dwordx4 v12, s[40:43], s48 offen offset:2048 lds
    buffer_load_dwordx4 v13, s[40:43], s48 offen offset:3072 lds
    s_add_u32 m0, s57, 0
    s_nop 0
    buffer_load_dwordx4 v14, s[44:47], s49 offen offset:0 lds
    buffer_load_dwordx4 v15, s[44:47], s49 offen offset:1024 lds
    buffer_load_dwordx4 v16, s[44:47], s49 offen offset:2048 lds
    buffer_load_dwordx4 v17, s[44:47], s49 offen offset:3072 lds
    s_waitcnt vmcnt(16)
    s_barrier
    s_lshl_b32 s48, s63, s7
    s_add_u32 s48, s48, s60
    s_mul_i32 s49, s63, s62
    s_add_u32 s49, s49, s61
    s_add_u32 s63, s63, 1
    s_cmp_eq_u32 s63, 9
    s_cselect_b32 s63, 0, s63
    s_add_u32 m0, s56, 32768
    s_nop 0
    buffer_load_dwordx4 v10, s[40:43], s48 offen offset:0 lds
    buffer_load_dwordx4 v11, s[40:43], s48 offen offset:1024 lds
    buffer_load_dwordx4 v12, s[40:43], s48 offen offset:2048 lds
    buffer_load_dwordx4 v13, s[40:43], s48 offen offset:3072 lds
    s_add_u32 m0, s57, 32768
    s_nop 0
    buffer_load_dwordx4 v14, s[44:47], s49 offen offset:0 lds
    buffer_load_dwordx4 v15, s[44:47], s49 offen offset:1024 lds
    buffer_load_dwordx4 v16, s[44:47], s49 offen offset:2048 lds
    buffer_load_dwordx4 v17, s[44:47], s49 offen offset:3072 lds
    s_lshl_b32 s48, s63, s7
    s_add_u32 s48, s48, s60
    s_mul_i32 s49, s63, s62
    s_add_u32 s49, s49, s61
    s_add_u32 s63, s63, 1
    s_cmp_eq_u32 s63, 9
    s_cselect_b32 s63, 0, s63
    s_add_u32 m0, s56, 65536
    s_nop 0
    buffer_load_dwordx4 v10, s[40:43], s48 offen offset:0 lds
    buffer_load_dwordx4 v11, s[40:43], s48 offen offset:1024 lds
    buffer_load_dwordx4 v12, s[40:43], s48 offen offset:2048 lds
    buffer_load_dwordx4 v13, s[40:43], s48 offen offset:3072 lds
    s_add_u32 m0, s57, 65536
    s_nop 0
    buffer_load_dwordx4 v14, s[44:47], s49 offen offset:0 lds
    buffer_load_dwordx4 v15, s[44:47], s49 offen offset:1024 lds
    buffer_load_dwordx4 v16, s[44:47], s49 offen offset:2048 lds
    buffer_load_dwordx4 v17, s[44:47], s49 offen offset:3072 lds
    v_and_b32 v2, 31, v0
    v_bfe_u32 v3, v0, 5, 1
    v_lshlrev_b32 v32, 15, v3
    v_lshl_add_u32 v32, v2, 4, v32
    v_lshlrev_b32 v33, 4, v1
    s_lshl_b32 s67, s69, 9
    v_lshlrev_b32 v34, 3, v3
    v_lshl_add_u32 v34, v2, 4, v34
    v_add_u32 v34, s67, v34
    s_mul_i32 s67, s69, 40960
    v_mul_u32_u24 v28, 20480, v3
    v_mul_u32_u24 v29, 304, v2
    v_add3_u32 v38, v28, v29, s67
    v_mov_b32 v44, 0x3f803f80
    v_mov_b32 v45, 0x3f803f80
    v_mov_b32 v46, 0x3f803f80
    v_mov_b32 v47, 0x3f803f80
    s_lshl_b32 s67, s34, 2
    s_lshr_b32 s64, s35, 3
    s_add_u32 s67, s67, s64
    s_mul_i32 s67, s67, 18
    v_lshrrev_b32 v28, 4, v1
    v_min_u32 v28, 2, v28
    v_mul_u32_u24 v28, 576, v28
    v_add_u32 v28, s67, v28
    v_and_b32 v29, 15, v1
    v_lshlrev_b32 v29, 7, v29
    v_lshrrev_b32 v30, 7, v28
    v_lshl_add_u32 v25, v30, 11, v29
    v_add_u32 v28, 17, v28
    v_lshrrev_b32 v30, 7, v28
    v_lshl_add_u32 v26, v30, 11, v29
    s_lshl_b32 s67, s69, 6
    v_add_u32 v28, s67, v1
    v_add_u32 v28, 0, v28
    v_mul_u32_u24 v29, 3450, v28
    s_waitcnt vmcnt(24)
    s_barrier
    s_lshl_b32 s48, s63, s7
    s_add_u32 s48, s48, s60
    s_mul_i32 s49, s63, s62
    s_add_u32 s49, s49, s61
    s_add_u32 s63, s63, 1
    s_cmp_eq_u32 s63, 9
    s_cselect_b32 s63, 0, s63
    s_add_u32 m0, s56, 98304
    s_nop 0
    buffer_load_dwordx4 v10, s[40:43], s48 offen offset:0 lds
    buffer_load_dwordx4 v11, s[40:43], s48 offen offset:1024 lds
    buffer_load_dwordx4 v12, s[40:43], s48 offen offset:2048 lds
    buffer_load_dwordx4 v13, s[40:43], s48 offen offset:3072 lds
    s_add_u32 m0, s57, 98304
    s_nop 0
    buffer_load_dwordx4 v14, s[44:47], s49 offen offset:0 lds
    buffer_load_dwordx4 v15, s[44:47], s49 offen offset:1024 lds
    buffer_load_dwordx4 v16, s[44:47], s49 offen offset:2048 lds
    buffer_load_dwordx4 v17, s[44:47], s49 offen offset:3072 lds
    v_lshrrev_b32 v29, 16, v29
    v_mul_u32_u24 v30, 19, v29
    v_sub_u32 v30, v28, v30
    v_cmp_gt_u32 vcc, 18, v30
    v_cmp_gt_u32 s[50:51], 32, v29
    v_and_b32 v31, 1, v29
    v_lshrrev_b32 v29, 1, v29
    v_mul_u32_u24 v29, 18432, v29
    v_lshl_add_u32 v29, v31, 4, v29
    v_lshl_add_u32 v35, v30, 5, v29
    s_and_b64 s[50:51], s[50:51], vcc
    s_lshl_b32 s67, s69, 6
    v_add_u32 v28, s67, v1
    v_add_u32 v28, 256, v28
    v_mul_u32_u24 v29, 3450, v28
    v_lshrrev_b32 v29, 16, v29
    v_mul_u32_u24 v30, 19, v29
    v_sub_u32 v30, v28, v30
    v_cmp_gt_u32 vcc, 18, v30
    v_cmp_gt_u32 s[52:53], 32, v29
    v_and_b32 v31, 1, v29
    v_lshrrev_b32 v29, 1, v29
    v_mul_u32_u24 v29, 18432, v29
    v_lshl_add_u32 v29, v31, 4, v29
    v_lshl_add_u32 v36, v30, 5, v29
    s_and_b64 s[52:53], s[52:53], vcc
    s_lshl_b32 s67, s65, 6
    v_add_u32 v28, s67, v1
    v_add_u32 v28, 512, v28
    v_mul_u32_u24 v29, 3450, v28
    v_lshrrev_b32 v29, 16, v29
    v_mul_u32_u24 v30, 19, v29
    v_sub_u32 v30, v28, v30
    v_cmp_gt_u32 vcc, 18, v30
    v_cmp_gt_u32 s[54:55], 32, v29
    v_and_b32 v31, 1, v29
    v_lshrrev_b32 v29, 1, v29
    v_mul_u32_u24 v29, 18432, v29
    v_lshl_add_u32 v29, v31, 4, v29
    s_waitcnt vmcnt(24)
    s_barrier
    s_lshl_b32 s48, s63, s7
    s_add_u32 s48, s48, s60
    s_mul_i32 s49, s63, s62
    s_add_u32 s49, s49, s61
    s_add_u32 s63, s63, 1
    s_cmp_eq_u32 s63, 9
    s_cselect_b32 s63, 0, s63
    s_add_u32 m0, s56, 131072
    s_nop 0
    buffer_load_dwordx4 v10, s[40:43], s48 offen offset:0 lds
    buffer_load_dwordx4 v11, s[40:43], s48 offen offset:1024 lds
    buffer_load_dwordx4 v12, s[40:43], s48 offen offset:2048 lds
    buffer_load_dwordx4 v13, s[40:43], s48 offen offset:3072 lds
    s_add_u32 m0, s57, 131072
    s_nop 0
    buffer_load_dwordx4 v14, s[44:47], s49 offen offset:0 lds
    buffer_load_dwordx4 v15, s[44:47], s49 offen offset:1024 lds
    buffer_load_dwordx4 v16, s[44:47], s49 offen offset:2048 lds
    buffer_load_dwordx4 v17, s[44:47], s49 offen offset:3072 lds
    v_lshl_add_u32 v37, v30, 5, v29
    s_and_b64 s[54:55], s[54:55], vcc
    v_lshrrev_b32 v30, 3, v1
    v_lshlrev_b32 v30, 12, v30
    v_bfe_u32 v31, v1, 4, 1
    v_lshlrev_b32 v31, 2, v31
    v_and_b32 v29, 7, v1
    v_xor_b32 v31, v31, v29
    v_lshl_add_u32 v228, v31, 4, v30
    v_add_u32 v229, 31744, v228
    v_add_u32 v230, 63488, v228
    v_add_u32 v231, 95232, v228
    v_lshrrev_b32 v30, 3, v1
    v_mul_u32_u24 v30, 1152, v30
    v_lshrrev_b32 v31, 4, v1
    v_and_b32 v29, 7, v1
    v_xor_b32 v31, v31, v29
    v_lshl_add_u32 v232, v31, 4, v30
    v_xor_b32 v31, 64, v232
    v_add_u32 v233, 8192, v31
    v_add_u32 v234, 16384, v232
    v_add_u32 v235, 24576, v31
    v_add_u32 v236, 36864, v232
    v_add_u32 v237, 45056, v31
    s_lshl_b32 s67, s69, 8
    v_xor_b32 v238, s67, v32
    v_xor_b32 v239, 512, v238
    v_bfe_u32 v28, v1, 2, 2
    v_lshl_add_u32 v28, v3, 3, v28
    v_mul_u32_u24 v28, 192, v28
    v_bfe_u32 v29, v1, 4, 1
    v_lshl_add_u32 v28, v29, 5, v28
    v_and_b32 v29, 3, v1
    v_lshl_add_u32 v28, v29, 3, v28
    s_mul_i32 s67, s69, 20480
    v_add_u32 v240, s67, v28
    s_waitcnt vmcnt(24)
    s_barrier
    s_lshl_b32 s48, s63, s7
    s_add_u32 s48, s48, s60
    s_mul_i32 s49, s63, s62
    s_add_u32 s49, s49, s61
    s_add_u32 s63, s63, 1
    s_cmp_eq_u32 s63, 9
    s_cselect_b32 s63, 0, s63
    s_add_u32 m0, s56, 0
    s_nop 0
    buffer_load_dwordx4 v10, s[40:43], s48 offen offset:0 lds
    buffer_load_dwordx4 v11, s[40:43], s48 offen offset:1024 lds
    buffer_load_dwordx4 v12, s[40:43], s48 offen offset:2048 lds
    buffer_load_dwordx4 v13, s[40:43], s48 offen offset:3072 lds
    s_add_u32 m0, s57, 0
    s_nop 0
    buffer_load_dwordx4 v14, s[44:47], s49 offen offset:0 lds
    buffer_load_dwordx4 v15, s[44:47], s49 offen offset:1024 lds
    buffer_load_dwordx4 v16, s[44:47], s49 offen offset:2048 lds
    buffer_load_dwordx4 v17, s[44:47], s49 offen offset:3072 lds
    v_mov_b32 v241, s69
    v_add_u32 v28, 0, v1
    v_mul_u32_u24 v30, 5462, v28
    v_lshrrev_b32 v30, 16, v30
    v_mul_u32_u24 v29, 12, v30
    v_sub_u32 v29, v28, v29
    v_bfe_u32 v31, v30, 3, 1
    v_lshlrev_b32 v28, 2, v31
    v_bfe_u32 v31, v30, 2, 1
    v_lshl_add_u32 v28, v31, 3, v28
    v_and_b32 v31, 3, v30
    v_add_u32 v28, v28, v31
    v_mul_u32_u24 v28, 1152, v28
    v_lshl_add_u32 v242, v29, 4, v28
    v_lshrrev_b32 v28, 1, v30
    v_mul_u32_u24 v28, 18, v28
    v_and_b32 v31, 1, v30
    v_add_u32 v28, v28, v31
    v_add_u32 v28, 16, v28
    v_cmp_eq_u32 vcc, 3, v241
    v_mul_u32_u24 v28, 1152, v28
    v_lshl_add_u32 v28, v29, 4, v28
    v_cndmask_b32 v245, v242, v28, vcc
    v_add_u32 v28, 64, v1
    v_mul_u32_u24 v30, 5462, v28
    v_lshrrev_b32 v30, 16, v30
    v_mul_u32_u24 v29, 12, v30
    v_sub_u32 v29, v28, v29
    v_bfe_u32 v31, v30, 3, 1
    v_lshlrev_b32 v28, 2, v31
    v_bfe_u32 v31, v30, 2, 1
    v_lshl_add_u32 v28, v31, 3, v28
    v_and_b32 v31, 3, v30
    v_add_u32 v28, v28, v31
    v_mul_u32_u24 v28, 1152, v28
    v_lshl_add_u32 v243, v29, 4, v28
    s_waitcnt vmcnt(24)
    s_barrier
    s_cmp_ge_u32 s96, 6
    s_cselect_b32 s44, s18, s16
    s_cselect_b32 s45, s19, s17
    s_cselect_b32 s61, 6, 0
    s_mov_b32 s46, 663552
    s_mov_b32 s47, 0x00020000
    s_sub_u32 s61, s96, s61
    s_lshl_b32 s61, s61, 2
    s_add_u32 s61, s61, s69
    s_mul_i32 s61, s61, 27648
    s_bitcmp1_b32 s97, 1
    s_cselect_b32 s60, s66, 1073741824
    s_cselect_b32 s61, s61, 1073741824
    s_mov_b32 s62, 128
    s_mov_b32 s7, 7
    s_mul_i32 s57, s69, 3072
    s_add_u32 s57, s57, 16384
    s_mov_b32 s40, s10
    s_mov_b32 s41, s11
    s_mov_b32 s42, 2359296
    s_mov_b32 s43, 0x00020000
    s_lshl_b32 s48, s63, s7
    s_add_u32 s48, s48, s60
    s_mul_i32 s49, s63, s62
    s_add_u32 s49, s49, s61
    s_add_u32 s63, s63, 1
    s_cmp_eq_u32 s63, 9
    s_cselect_b32 s63, 0, s63
    s_add_u32 m0, s56, 32768
    s_nop 0
    buffer_load_dwordx4 v18, s[40:43], s48 offen offset:0 lds
    buffer_load_dwordx4 v19, s[40:43], s48 offen offset:1024 lds
    buffer_load_dwordx4 v20, s[40:43], s48 offen offset:2048 lds
    buffer_load_dwordx4 v21, s[40:43], s48 offen offset:3072 lds
    s_add_u32 m0, s57, 32768
    s_nop 0
    buffer_load_dwordx4 v22, s[44:47], s49 offen offset:0 lds
    buffer_load_dwordx4 v23, s[44:47], s49 offen offset:1024 lds
    buffer_load_dwordx4 v24, s[44:47], s49 offen offset:2048 lds
    v_lshrrev_b32 v28, 1, v30
    v_mul_u32_u24 v28, 18, v28
    v_and_b32 v31, 1, v30
    v_add_u32 v28, v28, v31
    v_add_u32 v28, 16, v28
    v_cmp_eq_u32 vcc, 3, v241
    v_mul_u32_u24 v28, 1152, v28
    v_lshl_add_u32 v28, v29, 4, v28
    v_cndmask_b32 v246, v243, v28, vcc
    v_add_u32 v28, 128, v1
    v_mul_u32_u24 v30, 5462, v28
    v_lshrrev_b32 v30, 16, v30
    v_mul_u32_u24 v29, 12, v30
    v_sub_u32 v29, v28, v29
    v_bfe_u32 v31, v30, 3, 1
    v_lshlrev_b32 v28, 2, v31
    v_bfe_u32 v31, v30, 2, 1
    v_lshl_add_u32 v28, v31, 3, v28
    v_and_b32 v31, 3, v30
    v_add_u32 v28, v28, v31
    v_mul_u32_u24 v28, 1152, v28
    v_lshl_add_u32 v244, v29, 4, v28
    v_lshrrev_b32 v28, 1, v30
    v_mul_u32_u24 v28, 18, v28
    v_and_b32 v31, 1, v30
    v_add_u32 v28, v28, v31
    v_add_u32 v28, 16, v28
    v_cmp_eq_u32 vcc, 3, v241
    v_mul_u32_u24 v28, 1152, v28
    v_lshl_add_u32 v28, v29, 4, v28
    v_cndmask_b32 v247, v244, v28, vcc
    v_and_b32 v28, 31, v1
    v_lshrrev_b32 v29, 5, v1
    v_lshl_add_u32 v28, v29, 6, v28
    v_lshlrev_b32 v254, 12, v28
    v_lshlrev_b32 v255, 7, v1
    s_waitcnt vmcnt(23)
    s_barrier
    s_lshl_b32 s48, s63, s7
    s_add_u32 s48, s48, s60
    s_mul_i32 s49, s63, s62
    s_add_u32 s49, s49, s61
    s_add_u32 s63, s63, 1
    s_cmp_eq_u32 s63, 9
    s_cselect_b32 s63, 0, s63
    s_add_u32 m0, s56, 65536
    s_nop 0
    buffer_load_dwordx4 v18, s[40:43], s48 offen offset:0 lds
    buffer_load_dwordx4 v19, s[40:43], s48 offen offset:1024 lds
    buffer_load_dwordx4 v20, s[40:43], s48 offen offset:2048 lds
    buffer_load_dwordx4 v21, s[40:43], s48 offen offset:3072 lds
    s_add_u32 m0, s57, 65536
    s_nop 0
    buffer_load_dwordx4 v22, s[44:47], s49 offen offset:0 lds
    buffer_load_dwordx4 v23, s[44:47], s49 offen offset:1024 lds
    buffer_load_dwordx4 v24, s[44:47], s49 offen offset:2048 lds
    s_and_b32 s64, s95, 1
    s_lshl_b32 s64, s64, 4
    s_waitcnt lgkmcnt(0)
    s_lshr_b32 s4, s4, s64
    s_lshr_b32 s5, s5, s64
    s_lshr_b32 s6, s6, s64
    v_lshlrev_b32 v5, 16, s4
    v_lshlrev_b32 v6, 16, s5
    v_lshlrev_b32 v7, 16, s6
    v_mul_f32 v7, 0x3fb8aa3b, v7
    v_exp_f32 v7, v7
    s_nop 0
    v_cvt_pk_bf16_f32 v7, v7, v7
    v_and_b32 v7, 0xffff0000, v7
    v_mul_f32 v28, v7, v5
    v_mul_f32 v29, v7, v6
    v_mul_f32 v28, 0x3fb8aa3b, v28
    v_exp_f32 v28, v28
    v_mul_f32 v29, 0.15915494309189535, v29
    v_fract_f32 v29, v29
    v_cos_f32 v30, v29
    v_sin_f32 v31, v29
    s_nop 0
    v_mul_f32 v160, v28, v30
    v_mul_f32 v162, v28, v31
    v_add_f32 v30, -1.0, v160
    v_mul_f32 v28, v5, v5
    v_fma_f32 v28, v6, v6, v28
    v_rcp_f32 v28, v28
    v_mul_f32 v164, v30, v5
    v_fma_f32 v164, v162, v6, v164
    v_mul_f32 v166, v162, v5
    v_fma_f32 v166, -v30, v6, v166
    v_add_f32 v28, v28, v28
    v_mul_f32 v164, v164, v28
    v_mul_f32 v166, v166, v28
    s_waitcnt vmcnt(22)
    s_barrier
    s_lshl_b32 s48, s63, s7
    s_add_u32 s48, s48, s60
    s_mul_i32 s49, s63, s62
    s_add_u32 s49, s49, s61
    s_add_u32 s63, s63, 1
    s_cmp_eq_u32 s63, 9
    s_cselect_b32 s63, 0, s63
    s_add_u32 m0, s56, 98304
    s_nop 0
    buffer_load_dwordx4 v18, s[40:43], s48 offen offset:0 lds
    buffer_load_dwordx4 v19, s[40:43], s48 offen offset:1024 lds
    buffer_load_dwordx4 v20, s[40:43], s48 offen offset:2048 lds
    buffer_load_dwordx4 v21, s[40:43], s48 offen offset:3072 lds
    s_add_u32 m0, s57, 98304
    s_nop 0
    buffer_load_dwordx4 v22, s[44:47], s49 offen offset:0 lds
    buffer_load_dwordx4 v23, s[44:47], s49 offen offset:1024 lds
    buffer_load_dwordx4 v24, s[44:47], s49 offen offset:2048 lds
    v_sub_f32 v162, 0, v162
    v_mov_b32 v161, v160
    v_mov_b32 v163, v162
    v_mov_b32 v165, v164
    v_mov_b32 v167, v166
    v_mul_f32 v28, v162, v162
    v_mul_f32 v169, v160, v162
    v_fma_f32 v168, v160, v160, -v28
    v_add_f32 v169, v169, v169
    v_mul_f32 v28, v169, v169
    v_mul_f32 v169, v168, v169
    v_fma_f32 v168, v168, v168, -v28
    v_add_f32 v169, v169, v169
    v_mul_f32 v28, v169, v169
    v_mul_f32 v169, v168, v169
    v_fma_f32 v168, v168, v168, -v28
    v_add_f32 v169, v169, v169
    v_mul_f32 v28, v169, v169
    v_mul_f32 v171, v168, v169
    v_fma_f32 v170, v168, v168, -v28
    v_add_f32 v171, v171, v171
    v_mul_f32 v28, v171, v171
    v_mul_f32 v173, v170, v171
    v_fma_f32 v172, v170, v170, -v28
    v_add_f32 v173, v173, v173
    v_mul_f32 v28, v173, v173
    v_mul_f32 v175, v172, v173
    v_fma_f32 v174, v172, v172, -v28
    v_add_f32 v175, v175, v175
    v_mul_f32 v28, v175, v175
    v_mul_f32 v177, v174, v175
    v_fma_f32 v176, v174, v174, -v28
    v_add_f32 v177, v177, v177
    v_mul_f32 v28, v177, v177
    v_mul_f32 v179, v176, v177
    v_fma_f32 v178, v176, v176, -v28
    s_waitcnt vmcnt(21)
    s_barrier
    s_load_dword s94, s[30:31], 0
    s_lshl_b32 s48, s63, s7
    s_add_u32 s48, s48, s60
    s_mul_i32 s49, s63, s62
    s_add_u32 s49, s49, s61
    s_add_u32 s63, s63, 1
    s_cmp_eq_u32 s63, 9
    s_cselect_b32 s63, 0, s63
    s_add_u32 m0, s56, 131072
    s_nop 0
    buffer_load_dwordx4 v18, s[40:43], s48 offen offset:0 lds
    buffer_load_dwordx4 v19, s[40:43], s48 offen offset:1024 lds
    buffer_load_dwordx4 v20, s[40:43], s48 offen offset:2048 lds
    buffer_load_dwordx4 v21, s[40:43], s48 offen offset:3072 lds
    s_add_u32 m0, s57, 131072
    s_nop 0
    buffer_load_dwordx4 v22, s[44:47], s49 offen offset:0 lds
    buffer_load_dwordx4 v23, s[44:47], s49 offen offset:1024 lds
    buffer_load_dwordx4 v24, s[44:47], s49 offen offset:2048 lds
    v_add_f32 v179, v179, v179
    v_mul_f32 v28, v179, v179
    v_mul_f32 v181, v178, v179
    v_fma_f32 v180, v178, v178, -v28
    v_add_f32 v181, v181, v181
    v_lshlrev_b32 v182, 2, v1
    s_mov_b32 s64, 73728
    v_lshrrev_b32 v28, 1, v1
    v_mul_lo_u32 v39, v28, s64
    v_and_b32 v28, 1, v1
    v_mul_u32_u24 v28, 18432, v28
    v_add_u32 v39, v39, v28
    s_mul_i32 s67, s69, 18432
    s_add_u32 s67, s67, 60416
    v_add_u32 v4, s67, v33
    s_xor_b32 s67, s69, 1
    s_mul_i32 s67, s67, 18432
    s_add_u32 s67, s67, 66560
    v_add_u32 v5, s67, v33
    s_xor_b32 s67, s69, 2
    s_mul_i32 s67, s67, 18432
    s_add_u32 s67, s67, 72704
    v_add_u32 v6, s67, v33
    s_xor_b32 s67, s69, 3
    s_mul_i32 s67, s67, 18432
    s_add_u32 s67, s67, 78848
    v_add_u32 v7, s67, v33
    v_mul_u32_u24 v8, 18432, v3
    v_lshl_add_u32 v8, v2, 2, v8
    s_waitcnt vmcnt(21)
    s_barrier
    s_lshl_b32 s48, s63, s7
    s_add_u32 s48, s48, s60
    s_mul_i32 s49, s63, s62
    s_add_u32 s49, s49, s61
    s_add_u32 s63, s63, 1
    s_cmp_eq_u32 s63, 9
    s_cselect_b32 s63, 0, s63
    s_add_u32 m0, s56, 0
    s_nop 0
    buffer_load_dwordx4 v18, s[40:43], s48 offen offset:0 lds
    buffer_load_dwordx4 v19, s[40:43], s48 offen offset:1024 lds
    buffer_load_dwordx4 v20, s[40:43], s48 offen offset:2048 lds
    buffer_load_dwordx4 v21, s[40:43], s48 offen offset:3072 lds
    s_add_u32 m0, s57, 0
    s_nop 0
    buffer_load_dwordx4 v22, s[44:47], s49 offen offset:0 lds
    buffer_load_dwordx4 v23, s[44:47], s49 offen offset:1024 lds
    buffer_load_dwordx4 v24, s[44:47], s49 offen offset:2048 lds
    s_waitcnt vmcnt(21)
    s_barrier
    s_lshl_b32 s48, s63, s7
    s_add_u32 s48, s48, s60
    s_mul_i32 s49, s63, s62
    s_add_u32 s49, s49, s61
    s_add_u32 s63, s63, 1
    s_cmp_eq_u32 s63, 9
    s_cselect_b32 s63, 0, s63
    s_add_u32 m0, s56, 32768
    s_nop 0
    buffer_load_dwordx4 v18, s[40:43], s48 offen offset:0 lds
    buffer_load_dwordx4 v19, s[40:43], s48 offen offset:1024 lds
    buffer_load_dwordx4 v20, s[40:43], s48 offen offset:2048 lds
    buffer_load_dwordx4 v21, s[40:43], s48 offen offset:3072 lds
    s_add_u32 m0, s57, 32768
    s_nop 0
    buffer_load_dwordx4 v22, s[44:47], s49 offen offset:0 lds
    buffer_load_dwordx4 v23, s[44:47], s49 offen offset:1024 lds
    buffer_load_dwordx4 v24, s[44:47], s49 offen offset:2048 lds
    s_waitcnt vmcnt(21)
    s_barrier
    s_waitcnt lgkmcnt(0)
    s_cmp_lg_u32 s94, 0
    s_cbranch_scc1 L_nond_2
    s_mov_b32 s68, 0x40000
    v_mov_b32 v42, 0
L_non_1:
    global_load_dword v40, v42, s[30:31] sc1
    s_waitcnt vmcnt(0)
    v_readfirstlane_b32 s94, v40
    s_sub_u32 s68, s68, 1
    s_cmp_eq_u32 s68, 0
    s_cbranch_scc1 L_nond_2
    s_sleep 4
    s_cmp_eq_u32 s94, 0
    s_cbranch_scc1 L_non_1
L_nond_2:
    s_cmp_lg_u32 s69, 0
    s_cbranch_scc1 L_h_nopq
    s_bitcmp1_b32 s97, 0
    s_cbranch_scc0 L_h_nopq
    s_lshl_b32 s48, s59, 4
    s_add_u32 s48, s48, s58
    s_lshl_b32 s48, s48, 7
    s_add_u32 s48, s48, 18874368
    v_lshlrev_b32 v42, 7, v1
    v_mov_b32 v43, s94
    s_mov_b32 exec_lo, 0x1
    s_mov_b32 exec_hi, 0x0
    buffer_store_dword v43, v42, s[36:39], s48 offen sc1
    s_mov_b64 exec, -1
L_h_nopq:
    s_lshl_b32 s48, s63, s7
    s_add_u32 s48, s48, s60
    s_mul_i32 s49, s63, s62
    s_add_u32 s49, s49, s61
    s_add_u32 s63, s63, 1
    s_cmp_eq_u32 s63, 9
    s_cselect_b32 s63, 0, s63
    s_add_u32 m0, s56, 65536
    s_nop 0
    buffer_load_dwordx4 v18, s[40:43], s48 offen offset:0 lds
    buffer_load_dwordx4 v19, s[40:43], s48 offen offset:1024 lds
    buffer_load_dwordx4 v20, s[40:43], s48 offen offset:2048 lds
    buffer_load_dwordx4 v21, s[40:43], s48 offen offset:3072 lds
    s_add_u32 m0, s57, 65536
    s_nop 0
    buffer_load_dwordx4 v22, s[44:47], s49 offen offset:0 lds
    buffer_load_dwordx4 v23, s[44:47], s49 offen offset:1024 lds
    buffer_load_dwordx4 v24, s[44:47], s49 offen offset:2048 lds
    s_waitcnt vmcnt(21)
    s_barrier
    s_lshl_b32 s48, s63, s7
    s_add_u32 s48, s48, s60
    s_mul_i32 s49, s63, s62
    s_add_u32 s49, s49, s61
    s_add_u32 s63, s63, 1
    s_cmp_eq_u32 s63, 9
    s_cselect_b32 s63, 0, s63
    s_add_u32 m0, s56, 98304
    s_nop 0
    buffer_load_dwordx4 v18, s[40:43], s48 offen offset:0 lds
    buffer_load_dwordx4 v19, s[40:43], s48 offen offset:1024 lds
    buffer_load_dwordx4 v20, s[40:43], s48 offen offset:2048 lds
    buffer_load_dwordx4 v21, s[40:43], s48 offen offset:3072 lds
    s_add_u32 m0, s57, 98304
    s_nop 0
    buffer_load_dwordx4 v22, s[44:47], s49 offen offset:0 lds
    buffer_load_dwordx4 v23, s[44:47], s49 offen offset:1024 lds
    buffer_load_dwordx4 v24, s[44:47], s49 offen offset:2048 lds
    s_waitcnt vmcnt(21)
    s_barrier
    s_lshl_b32 s48, s63, s7
    s_add_u32 s48, s48, s60
    s_mul_i32 s49, s63, s62
    s_add_u32 s49, s49, s61
    s_add_u32 s63, s63, 1
    s_cmp_eq_u32 s63, 9
    s_cselect_b32 s63, 0, s63
    s_add_u32 m0, s56, 131072
    s_nop 0
    buffer_load_dwordx4 v18, s[40:43], s48 offen offset:0 lds
    buffer_load_dwordx4 v19, s[40:43], s48 offen offset:1024 lds
    buffer_load_dwordx4 v20, s[40:43], s48 offen offset:2048 lds
    buffer_load_dwordx4 v21, s[40:43], s48 offen offset:3072 lds
    s_add_u32 m0, s57, 131072
    s_nop 0
    buffer_load_dwordx4 v22, s[44:47], s49 offen offset:0 lds
    buffer_load_dwordx4 v23, s[44:47], s49 offen offset:1024 lds
    buffer_load_dwordx4 v24, s[44:47], s49 offen offset:2048 lds
    s_waitcnt vmcnt(21)
    s_barrier
    s_waitcnt vmcnt(14)
    s_barrier
    s_lshl_b32 s40, s34, 2
    s_lshr_b32 s41, s35, 3
    s_add_u32 s40, s40, s41
    s_and_b32 s47, s35, 7
    s_mul_i32 s42, s40, 9
    s_lshr_b32 s42, s42, 2
    s_and_b32 s45, s40, 3
    s_lshr_b32 s46, s45, 1
    s_add_u32 s43, s42, s46
    s_xor_b32 s44, s46, 1
    s_lshl_b32 s44, s44, 1
    s_add_u32 s44, s44, s42
    s_lshl_b32 s44, s44, 15
    s_lshl_b32 s46, s46, 3
    s_add_u32 s44, s44, s46
    s_mov_b32 s67, 18874368
    s_lshl_b32 s60, s43, 15
    s_lshl_b32 s64, s69, 10
    s_add_u32 s60, s60, s64
    s_add_u32 s60, s60, 2359296
    s_add_u32 s61, s44, s64
    s_add_u32 s61, s61, 2359296
    s_mul_i32 s62, s40, 576
    s_add_u32 s62, s62, 4718592
    s_and_b32 s65, s69, 1
    s_lshl_b32 s65, s65, 10
    s_lshl_b32 s66, s69, 11
    s_cmp_lg_u32 s69, 0
    s_cbranch_scc1 L_h_nap
    buffer_load_dword v40, v25, s[36:39], s67 offen sc1
    buffer_load_dword v41, v26, s[36:39], s67 offen sc1
L_h_nap:
    s_waitcnt vmcnt(7)
    s_cmp_lg_u32 s69, 0
    s_cbranch_scc1 L_h_kv
    s_waitcnt vmcnt(0)
    v_cmp_eq_u32 vcc, s94, v40
    v_cmp_eq_u32 s[46:47], s94, v41
    s_and_b64 vcc, vcc, s[46:47]
    s_cmp_eq_u64 vcc, exec
    s_cbranch_scc1 L_h_kv
    s_mov_b32 s68, 262144
    s_mov_b32 exec_lo, 0xffffffff
    s_mov_b32 exec_hi, 0xffff
L_poll_3:
    buffer_load_dword v40, v25, s[36:39], s67 offen sc1
    buffer_load_dword v41, v26, s[36:39], s67 offen sc1
    s_waitcnt vmcnt(0)
    v_cmp_eq_u32 vcc, s94, v40
    v_cmp_eq_u32 s[46:47], s94, v41
    s_and_b64 vcc, vcc, s[46:47]
    s_cmp_eq_u64 vcc, exec
    s_cbranch_scc1 L_polld_4
    s_sleep 2
    s_sub_u32 s68, s68, 1
    s_cmp_lg_u32 s68, 0
    s_cbranch_scc1 L_poll_3
L_polld_4:
    s_mov_b64 exec, -1
L_h_kv:
    s_barrier
    s_add_u32 s49, s35, 0
    s_and_b32 s49, s49, 7
    s_lshl_b32 s63, s49, 12
    s_add_u32 s48, s61, s63
    buffer_load_dwordx2 v[48:49], v33, s[36:39], s48 offen sc1
    s_add_u32 s48, s60, s63
    s_add_u32 m0, s66, 0
    s_nop 0
    buffer_load_dwordx4 v32, s[36:39], s48 offen offset:0 sc1 lds
    s_add_u32 m0, s66, 512
    s_nop 0
    buffer_load_dwordx4 v32, s[36:39], s48 offen offset:512 sc1 lds
    s_mul_i32 s48, s49, 294912
    s_add_u32 s48, s48, s62
    s_add_u32 m0, s64, 10240
    s_mov_b64 exec, s[50:51]
    buffer_load_dwordx4 v35, s[36:39], s48 offen sc1 lds
    s_add_u32 m0, s64, 14336
    s_mov_b64 exec, s[52:53]
    buffer_load_dwordx4 v36, s[36:39], s48 offen sc1 lds
    s_cmp_ge_u32 s69, 2
    s_cbranch_scc1 L_sk_5
    s_add_u32 m0, s65, 18432
    s_mov_b64 exec, s[54:55]
    buffer_load_dwordx4 v37, s[36:39], s48 offen sc1 lds
L_sk_5:
    s_mov_b64 exec, -1
    s_waitcnt vmcnt(5)
    s_barrier
    s_add_u32 s49, s35, 1
    s_and_b32 s49, s49, 7
    s_lshl_b32 s63, s49, 12
    s_add_u32 s48, s61, s63
    buffer_load_dwordx2 v[50:51], v33, s[36:39], s48 offen sc1
    s_add_u32 s48, s60, s63
    s_add_u32 m0, s66, 20480
    s_nop 0
    buffer_load_dwordx4 v32, s[36:39], s48 offen offset:0 sc1 lds
    s_add_u32 m0, s66, 20992
    s_nop 0
    buffer_load_dwordx4 v32, s[36:39], s48 offen offset:512 sc1 lds
    s_mul_i32 s48, s49, 294912
    s_add_u32 s48, s48, s62
    s_add_u32 m0, s64, 30720
    s_mov_b64 exec, s[50:51]
    buffer_load_dwordx4 v35, s[36:39], s48 offen sc1 lds
    s_add_u32 m0, s64, 34816
    s_mov_b64 exec, s[52:53]
    buffer_load_dwordx4 v36, s[36:39], s48 offen sc1 lds
    s_cmp_ge_u32 s69, 2
    s_cbranch_scc1 L_sk_6
    s_add_u32 m0, s65, 38912
    s_mov_b64 exec, s[54:55]
    buffer_load_dwordx4 v37, s[36:39], s48 offen sc1 lds
L_sk_6:
    s_mov_b64 exec, -1
    s_barrier
    ds_write_b128 v38, v[44:47] offset:10528
    s_setprio 3
    s_lshl_b32 s49, s69, 2
    s_add_u32 s49, s49, 163712
    v_mov_b32 v9, s49
    v_mov_b32 v28, 0
    v_lshlrev_b32 v29, 2, v2
    v_add_u32 v29, 163712, v29
    ds_write_b32 v29, v28
    s_waitcnt vmcnt(0)
    ds_write_b64 v34, v[48:49] offset:8192
    ds_write_b64 v34, v[50:51] offset:28672
    s_waitcnt lgkmcnt(0)
    s_barrier
    s_setprio 0
    s_add_u32 s49, s35, 2
    s_and_b32 s49, s49, 7
    s_lshl_b32 s63, s49, 12
    s_add_u32 s48, s61, s63
    buffer_load_dwordx2 v[52:53], v33, s[36:39], s48 offen sc1
    s_add_u32 s48, s60, s63
    s_add_u32 m0, s66, 40960
    s_nop 0
    buffer_load_dwordx4 v32, s[36:39], s48 offen offset:0 sc1 lds
    s_add_u32 m0, s66, 41472
    s_nop 0
    buffer_load_dwordx4 v32, s[36:39], s48 offen offset:512 sc1 lds
    s_mul_i32 s48, s49, 294912
    s_add_u32 s48, s48, s62
    s_add_u32 m0, s64, 51200
    s_mov_b64 exec, s[50:51]
    buffer_load_dwordx4 v35, s[36:39], s48 offen sc1 lds
    s_add_u32 m0, s64, 55296
    s_mov_b64 exec, s[52:53]
    buffer_load_dwordx4 v36, s[36:39], s48 offen sc1 lds
    s_cmp_ge_u32 s69, 2
    s_cbranch_scc1 L_sk_7
    s_add_u32 m0, s65, 59392
    s_mov_b64 exec, s[54:55]
    buffer_load_dwordx4 v37, s[36:39], s48 offen sc1 lds
L_sk_7:
    s_mov_b64 exec, -1
    s_add_u32 s49, s35, 3
    s_and_b32 s49, s49, 7
    s_lshl_b32 s63, s49, 12
    s_add_u32 s48, s61, s63
    buffer_load_dwordx2 v[54:55], v33, s[36:39], s48 offen sc1
    s_add_u32 s48, s60, s63
    s_add_u32 m0, s66, 61440
    s_nop 0
    buffer_load_dwordx4 v32, s[36:39], s48 offen offset:0 sc1 lds
    s_add_u32 m0, s66, 61952
    s_nop 0
    buffer_load_dwordx4 v32, s[36:39], s48 offen offset:512 sc1 lds
    s_mul_i32 s48, s49, 294912
    s_add_u32 s48, s48, s62
    s_add_u32 m0, s64, 71680
    s_mov_b64 exec, s[50:51]
    buffer_load_dwordx4 v35, s[36:39], s48 offen sc1 lds
    s_add_u32 m0, s64, 75776
    s_mov_b64 exec, s[52:53]
    buffer_load_dwordx4 v36, s[36:39], s48 offen sc1 lds
    s_cmp_ge_u32 s69, 2
    s_cbranch_scc1 L_sk_8
    s_add_u32 m0, s65, 79872
    s_mov_b64 exec, s[54:55]
    buffer_load_dwordx4 v37, s[36:39], s48 offen sc1 lds
L_sk_8:
    s_mov_b64 exec, -1
    s_add_u32 s49, s35, 4
    s_and_b32 s49, s49, 7
    s_lshl_b32 s63, s49, 12
    s_add_u32 s48, s61, s63
    buffer_load_dwordx2 v[56:57], v33, s[36:39], s48 offen sc1
    s_add_u32 s48, s60, s63
    s_add_u32 m0, s66, 81920
    s_nop 0
    buffer_load_dwordx4 v32, s[36:39], s48 offen offset:0 sc1 lds
    s_add_u32 m0, s66, 82432
    s_nop 0
    buffer_load_dwordx4 v32, s[36:39], s48 offen offset:512 sc1 lds
    s_mul_i32 s48, s49, 294912
    s_add_u32 s48, s48, s62
    s_add_u32 m0, s64, 92160
    s_mov_b64 exec, s[50:51]
    buffer_load_dwordx4 v35, s[36:39], s48 offen sc1 lds
    s_add_u32 m0, s64, 96256
    s_mov_b64 exec, s[52:53]
    buffer_load_dwordx4 v36, s[36:39], s48 offen sc1 lds
    s_cmp_ge_u32 s69, 2
    s_cbranch_scc1 L_sk_9
    s_add_u32 m0, s65, 100352
    s_mov_b64 exec, s[54:55]
    buffer_load_dwordx4 v37, s[36:39], s48 offen sc1 lds
L_sk_9:
    s_mov_b64 exec, -1
    s_add_u32 s49, s35, 5
    s_and_b32 s49, s49, 7
    s_lshl_b32 s63, s49, 12
    s_add_u32 s48, s61, s63
    buffer_load_dwordx2 v[58:59], v33, s[36:39], s48 offen sc1
    s_add_u32 s48, s60, s63
    s_add_u32 m0, s66, 102400
    s_nop 0
    buffer_load_dwordx4 v32, s[36:39], s48 offen offset:0 sc1 lds
    s_add_u32 m0, s66, 102912
    s_nop 0
    buffer_load_dwordx4 v32, s[36:39], s48 offen offset:512 sc1 lds
    s_mul_i32 s48, s49, 294912
    s_add_u32 s48, s48, s62
    s_add_u32 m0, s64, 112640
    s_mov_b64 exec, s[50:51]
    buffer_load_dwordx4 v35, s[36:39], s48 offen sc1 lds
    s_add_u32 m0, s64, 116736
    s_mov_b64 exec, s[52:53]
    buffer_load_dwordx4 v36, s[36:39], s48 offen sc1 lds
    s_cmp_ge_u32 s69, 2
    s_cbranch_scc1 L_sk_10
    s_add_u32 m0, s65, 120832
    s_mov_b64 exec, s[54:55]
    buffer_load_dwordx4 v37, s[36:39], s48 offen sc1 lds
L_sk_10:
    s_mov_b64 exec, -1
    s_add_u32 s49, s35, 6
    s_and_b32 s49, s49, 7
    s_lshl_b32 s63, s49, 12
    s_add_u32 s48, s61, s63
    buffer_load_dwordx2 v[60:61], v33, s[36:39], s48 offen sc1
    s_add_u32 s48, s60, s63
    s_add_u32 m0, s66, 122880
    s_nop 0
    buffer_load_dwordx4 v32, s[36:39], s48 offen offset:0 sc1 lds
    s_add_u32 m0, s66, 123392
    s_nop 0
    buffer_load_dwordx4 v32, s[36:39], s48 offen offset:512 sc1 lds
    s_mul_i32 s48, s49, 294912
    s_add_u32 s48, s48, s62
    s_add_u32 m0, s64, 133120
    s_mov_b64 exec, s[50:51]
    buffer_load_dwordx4 v35, s[36:39], s48 offen sc1 lds
    s_add_u32 m0, s64, 137216
    s_mov_b64 exec, s[52:53]
    buffer_load_dwordx4 v36, s[36:39], s48 offen sc1 lds
    s_cmp_ge_u32 s69, 2
    s_cbranch_scc1 L_sk_11
    s_add_u32 m0, s65, 141312
    s_mov_b64 exec, s[54:55]
    buffer_load_dwordx4 v37, s[36:39], s48 offen sc1 lds
L_sk_11:
    s_mov_b64 exec, -1
    s_add_u32 s49, s35, 7
    s_and_b32 s49, s49, 7
    s_lshl_b32 s63, s49, 12
    s_add_u32 s48, s61, s63
    buffer_load_dwordx2 v[62:63], v33, s[36:39], s48 offen sc1
    s_add_u32 s48, s60, s63
    s_add_u32 m0, s66, 143360
    s_nop 0
    buffer_load_dwordx4 v32, s[36:39], s48 offen offset:0 sc1 lds
    s_add_u32 m0, s66, 143872
    s_nop 0
    buffer_load_dwordx4 v32, s[36:39], s48 offen offset:512 sc1 lds
    s_mul_i32 s48, s49, 294912
    s_add_u32 s48, s48, s62
    s_add_u32 m0, s64, 153600
    s_mov_b64 exec, s[50:51]
    buffer_load_dwordx4 v35, s[36:39], s48 offen sc1 lds
    s_add_u32 m0, s64, 157696
    s_mov_b64 exec, s[52:53]
    buffer_load_dwordx4 v36, s[36:39], s48 offen sc1 lds
    s_cmp_ge_u32 s69, 2
    s_cbranch_scc1 L_sk_12
    s_add_u32 m0, s65, 161792
    s_mov_b64 exec, s[54:55]
    buffer_load_dwordx4 v37, s[36:39], s48 offen sc1 lds
L_sk_12:
    s_mov_b64 exec, -1
    s_waitcnt vmcnt(0)
    ds_write_b64 v34, v[52:53] offset:49152
    v_add_u32 v28, 69632, v34
    ds_write_b64 v28, v[54:55]
    v_add_u32 v28, 90112, v34
    ds_write_b64 v28, v[56:57]
    v_add_u32 v28, 110592, v34
    ds_write_b64 v28, v[58:59]
    v_add_u32 v28, 131072, v34
    ds_write_b64 v28, v[60:61]
    v_add_u32 v28, 151552, v34
    ds_write_b64 v28, v[62:63]
    s_waitcnt lgkmcnt(0)
    v_mov_b32 v28, 1
    ds_write_b32 v9, v28
    s_cmp_lg_u32 s69, 3
    s_cbranch_scc1 L_h_nopu
    s_bitcmp1_b32 s97, 1
    s_cbranch_scc0 L_h_nopu
    s_setprio 3
    s_cmp_ge_u32 s96, 6
    s_cselect_b32 s60, 4294944768, 0
    s_lshl_b32 s61, s96, 12
    s_add_u32 s60, s60, s61
    s_lshl_b32 s61, s58, 7
    s_add_u32 s60, s60, s61
    s_add_u32 s60, s60, 18903040
    v_mov_b32 v40, 163728
L_lw_13:
    ds_read_b32 v41, v40
    s_waitcnt lgkmcnt(0)
    v_readfirstlane_b32 s68, v41
    s_cmp_ge_u32 s68, 4
    s_cbranch_scc1 L_lwd_14
    s_sleep 2
    s_branch L_lw_13
L_lwd_14:
    v_lshlrev_b32 v42, 7, v1
    v_mov_b32 v43, s94
    s_mov_b32 exec_lo, 0x1
    s_mov_b32 exec_hi, 0x0
    buffer_store_dword v43, v42, s[36:39], s60 offen sc1
    s_mov_b64 exec, -1
L_h_nopu:
    s_setprio 3
    s_mov_b32 s68, 0
    s_cmp_ge_u32 s95, 576
    s_cbranch_scc1 L_h_scand
    s_mul_i32 s61, s95, 683
    s_lshr_b32 s61, s61, 16
    s_lshl_b32 s61, s61, 12
    s_add_u32 s61, s61, 18903040
    s_cmp_ge_u32 s35, 24
    s_cbranch_scc1 L_h_up
    s_cmp_eq_u32 s69, 3
    s_cbranch_scc1 L_h_up
    v_mov_b32 v40, 163756
L_lw_15:
    ds_read_b32 v41, v40
    s_waitcnt lgkmcnt(0)
    v_readfirstlane_b32 s68, v41
    s_cmp_ge_u32 s68, 1
    s_cbranch_scc1 L_lwd_16
    s_sleep 3
    s_branch L_lw_15
L_lwd_16:
    s_branch L_h_upd
L_h_up:
    v_lshlrev_b32 v42, 7, v1
    s_mov_b32 s68, 262144
    s_mov_b32 exec_lo, 0xffffffff
    s_mov_b32 exec_hi, 0x0
L_poll_17:
    buffer_load_dword v40, v42, s[36:39], s61 offen sc1
    s_waitcnt vmcnt(0)
    v_cmp_eq_u32 vcc, s94, v40
    s_cmp_eq_u64 vcc, exec
    s_cbranch_scc1 L_polld_18
    s_sleep 4
    s_sub_u32 s68, s68, 1
    s_cmp_lg_u32 s68, 0
    s_cbranch_scc1 L_poll_17
L_polld_18:
    s_mov_b64 exec, -1
    s_mov_b64 exec, 1
    v_mov_b32 v40, 163756
    v_mov_b32 v41, 1
    ds_add_u32 v40, v41
    s_mov_b64 exec, -1
L_h_upd:
    s_and_b32 s65, s69, 1
    s_cmp_ge_u32 s35, 24
    s_cselect_b32 s65, 0, s65
    s_mul_i32 s61, s65, 2359296
    s_lshl_b32 s62, s95, 4
    s_add_u32 s61, s61, s62
    s_add_u32 s61, s61, 9437184
    s_lshl_b32 s63, s95, 12
    s_lshl_b32 s62, s65, 11
    s_add_u32 s63, s63, s62
    s_add_u32 s63, s63, 14155776
    s_add_u32 s64, s63, 2359296
    s_lshl_b32 s60, s2, 7
    s_add_u32 s60, s60, 18927616
    s_add_u32 s62, s61, 0
    buffer_load_dwordx4 v[64:67], v39, s[36:39], s62 offen sc1
    s_add_u32 s62, s61, 9216
    buffer_load_dwordx4 v[68:71], v39, s[36:39], s62 offen sc1
    s_add_u32 s62, s61, 36864
    buffer_load_dwordx4 v[72:75], v39, s[36:39], s62 offen sc1
    s_add_u32 s62, s61, 46080
    buffer_load_dwordx4 v[76:79], v39, s[36:39], s62 offen sc1
    v_mov_b64 v[120:121], 0
    s_cmp_ge_u32 s35, 24
    s_cbranch_scc1 L_h_whole
    s_lshr_b32 s62, s69, 1
    s_lshl_b32 s62, s62, 4
    s_add_u32 s62, s62, 163776
    v_mov_b32 v22, s62
    s_waitcnt vmcnt(0)
    s_lshl_b32 s66, s35, 2
    s_add_u32 s66, s66, s69
    s_lshl_b32 s66, s66, 13
    s_mov_b32 s44, s8
    s_mov_b32 s45, s9
    s_mov_b32 s46, 663552
    s_mov_b32 s47, 0x00020000
    buffer_load_dword v14, v255, s[44:47], s66 offen
    s_lshr_b32 s67, s34, 2
    s_mul_i32 s67, s67, 331776
    s_add_u32 s68, s67, 331776
    s_add_u32 s67, s67, s66
    s_mov_b32 s48, s20
    s_mov_b32 s49, s21
    s_mov_b32 s50, s68
    s_mov_b32 s51, 0x00020000
    buffer_load_dword v14, v255, s[48:51], s67 offen
    s_mov_b32 s44, s22
    s_mov_b32 s45, s23
    s_mov_b32 s46, s68
    s_mov_b32 s47, 0x00020000
    buffer_load_dword v14, v255, s[44:47], s67 offen
    v_lshlrev_b32 v112, 16, v64
    v_and_b32 v113, 0xffff0000, v64
    v_lshlrev_b32 v114, 16, v72
    v_and_b32 v115, 0xffff0000, v72
    v_pk_mul_f32 v[80:81], v[164:165], v[112:113]
    v_pk_mul_f32 v[96:97], v[164:165], v[114:115] neg_lo:[1,0] neg_hi:[1,0]
    v_pk_fma_f32 v[80:81], v[166:167], v[114:115], v[80:81] neg_lo:[1,0,0] neg_hi:[1,0,0]
    v_pk_fma_f32 v[96:97], v[166:167], v[112:113], v[96:97] neg_lo:[1,0,0] neg_hi:[1,0,0]
    v_lshlrev_b32 v112, 16, v65
    v_and_b32 v113, 0xffff0000, v65
    v_lshlrev_b32 v114, 16, v73
    v_and_b32 v115, 0xffff0000, v73
    v_pk_mul_f32 v[82:83], v[164:165], v[112:113]
    v_pk_mul_f32 v[98:99], v[164:165], v[114:115] neg_lo:[1,0] neg_hi:[1,0]
    v_pk_fma_f32 v[82:83], v[166:167], v[114:115], v[82:83] neg_lo:[1,0,0] neg_hi:[1,0,0]
    v_pk_fma_f32 v[98:99], v[166:167], v[112:113], v[98:99] neg_lo:[1,0,0] neg_hi:[1,0,0]
    v_lshlrev_b32 v112, 16, v66
    v_and_b32 v113, 0xffff0000, v66
    v_lshlrev_b32 v114, 16, v74
    v_and_b32 v115, 0xffff0000, v74
    v_pk_mul_f32 v[84:85], v[164:165], v[112:113]
    v_pk_mul_f32 v[100:101], v[164:165], v[114:115] neg_lo:[1,0] neg_hi:[1,0]
    v_pk_fma_f32 v[84:85], v[166:167], v[114:115], v[84:85] neg_lo:[1,0,0] neg_hi:[1,0,0]
    v_pk_fma_f32 v[100:101], v[166:167], v[112:113], v[100:101] neg_lo:[1,0,0] neg_hi:[1,0,0]
    v_lshlrev_b32 v112, 16, v67
    v_and_b32 v113, 0xffff0000, v67
    v_lshlrev_b32 v114, 16, v75
    v_and_b32 v115, 0xffff0000, v75
    v_pk_mul_f32 v[86:87], v[164:165], v[112:113]
    v_pk_mul_f32 v[102:103], v[164:165], v[114:115] neg_lo:[1,0] neg_hi:[1,0]
    v_pk_fma_f32 v[86:87], v[166:167], v[114:115], v[86:87] neg_lo:[1,0,0] neg_hi:[1,0,0]
    v_pk_fma_f32 v[102:103], v[166:167], v[112:113], v[102:103] neg_lo:[1,0,0] neg_hi:[1,0,0]
    v_lshlrev_b32 v112, 16, v68
    v_and_b32 v113, 0xffff0000, v68
    v_lshlrev_b32 v114, 16, v76
    v_and_b32 v115, 0xffff0000, v76
    v_pk_mul_f32 v[88:89], v[164:165], v[112:113]
    v_pk_mul_f32 v[104:105], v[164:165], v[114:115] neg_lo:[1,0] neg_hi:[1,0]
    v_pk_fma_f32 v[88:89], v[166:167], v[114:115], v[88:89] neg_lo:[1,0,0] neg_hi:[1,0,0]
    v_pk_fma_f32 v[104:105], v[166:167], v[112:113], v[104:105] neg_lo:[1,0,0] neg_hi:[1,0,0]
    v_lshlrev_b32 v112, 16, v69
    v_and_b32 v113, 0xffff0000, v69
    v_lshlrev_b32 v114, 16, v77
    v_and_b32 v115, 0xffff0000, v77
    v_pk_mul_f32 v[90:91], v[164:165], v[112:113]
    v_pk_mul_f32 v[106:107], v[164:165], v[114:115] neg_lo:[1,0] neg_hi:[1,0]
    v_pk_fma_f32 v[90:91], v[166:167], v[114:115], v[90:91] neg_lo:[1,0,0] neg_hi:[1,0,0]
    v_pk_fma_f32 v[106:107], v[166:167], v[112:113], v[106:107] neg_lo:[1,0,0] neg_hi:[1,0,0]
    v_lshlrev_b32 v112, 16, v70
    v_and_b32 v113, 0xffff0000, v70
    v_lshlrev_b32 v114, 16, v78
    v_and_b32 v115, 0xffff0000, v78
    v_pk_mul_f32 v[92:93], v[164:165], v[112:113]
    v_pk_mul_f32 v[108:109], v[164:165], v[114:115] neg_lo:[1,0] neg_hi:[1,0]
    v_pk_fma_f32 v[92:93], v[166:167], v[114:115], v[92:93] neg_lo:[1,0,0] neg_hi:[1,0,0]
    v_pk_fma_f32 v[108:109], v[166:167], v[112:113], v[108:109] neg_lo:[1,0,0] neg_hi:[1,0,0]
    v_lshlrev_b32 v112, 16, v71
    v_and_b32 v113, 0xffff0000, v71
    v_lshlrev_b32 v114, 16, v79
    v_and_b32 v115, 0xffff0000, v79
    v_pk_mul_f32 v[94:95], v[164:165], v[112:113]
    v_pk_mul_f32 v[110:111], v[164:165], v[114:115] neg_lo:[1,0] neg_hi:[1,0]
    v_pk_fma_f32 v[94:95], v[166:167], v[114:115], v[94:95] neg_lo:[1,0,0] neg_hi:[1,0,0]
    v_pk_fma_f32 v[110:111], v[166:167], v[112:113], v[110:111] neg_lo:[1,0,0] neg_hi:[1,0,0]
    v_pk_fma_f32 v[112:113], v[160:161], v[80:81], v[82:83]
    v_pk_fma_f32 v[114:115], v[160:161], v[96:97], v[98:99]
    v_pk_fma_f32 v[112:113], v[162:163], v[96:97], v[112:113] neg_lo:[1,0,0] neg_hi:[1,0,0]
    v_pk_fma_f32 v[114:115], v[162:163], v[80:81], v[114:115]
    v_pk_fma_f32 v[116:117], v[160:161], v[112:113], v[84:85]
    v_pk_fma_f32 v[118:119], v[160:161], v[114:115], v[100:101]
    v_pk_fma_f32 v[116:117], v[162:163], v[114:115], v[116:117] neg_lo:[1,0,0] neg_hi:[1,0,0]
    v_pk_fma_f32 v[118:119], v[162:163], v[112:113], v[118:119]
    v_pk_fma_f32 v[112:113], v[160:161], v[116:117], v[86:87]
    v_pk_fma_f32 v[114:115], v[160:161], v[118:119], v[102:103]
    v_pk_fma_f32 v[112:113], v[162:163], v[118:119], v[112:113] neg_lo:[1,0,0] neg_hi:[1,0,0]
    v_pk_fma_f32 v[114:115], v[162:163], v[116:117], v[114:115]
    v_pk_fma_f32 v[116:117], v[160:161], v[112:113], v[88:89]
    v_pk_fma_f32 v[118:119], v[160:161], v[114:115], v[104:105]
    v_pk_fma_f32 v[116:117], v[162:163], v[114:115], v[116:117] neg_lo:[1,0,0] neg_hi:[1,0,0]
    v_pk_fma_f32 v[118:119], v[162:163], v[112:113], v[118:119]
    v_pk_fma_f32 v[112:113], v[160:161], v[116:117], v[90:91]
    v_pk_fma_f32 v[114:115], v[160:161], v[118:119], v[106:107]
    v_pk_fma_f32 v[112:113], v[162:163], v[118:119], v[112:113] neg_lo:[1,0,0] neg_hi:[1,0,0]
    v_pk_fma_f32 v[114:115], v[162:163], v[116:117], v[114:115]
    v_pk_fma_f32 v[116:117], v[160:161], v[112:113], v[92:93]
    v_pk_fma_f32 v[118:119], v[160:161], v[114:115], v[108:109]
    v_pk_fma_f32 v[116:117], v[162:163], v[114:115], v[116:117] neg_lo:[1,0,0] neg_hi:[1,0,0]
    v_pk_fma_f32 v[118:119], v[162:163], v[112:113], v[118:119]
    v_pk_fma_f32 v[112:113], v[160:161], v[116:117], v[94:95]
    v_pk_fma_f32 v[114:115], v[160:161], v[118:119], v[110:111]
    v_pk_fma_f32 v[112:113], v[162:163], v[118:119], v[112:113] neg_lo:[1,0,0] neg_hi:[1,0,0]
    v_pk_fma_f32 v[114:115], v[162:163], v[116:117], v[114:115]
    v_fma_f32 v116, v168, v112, v113
    v_fma_f32 v117, v168, v114, v115
    v_fma_f32 v116, -v169, v114, v116
    v_fma_f32 v117, v169, v112, v117
    s_cmp_eq_u32 s65, 0
    s_cbranch_scc1 L_h_nocy
L_h_cyw:
    ds_read_b128 v[24:27], v22
    s_waitcnt lgkmcnt(0)
    v_readfirstlane_b32 s62, v26
    s_cmp_eq_u32 s62, 0
    s_cbranch_scc0 L_h_cyd
    s_sleep 1
    s_branch L_h_cyw
L_h_cyd:
    v_mov_b64 v[120:121], v[24:25]
L_h_nocy:
    s_mov_b64 exec, 1
    v_fma_f32 v116, v170, v120, v116
    v_fma_f32 v117, v170, v121, v117
    v_fma_f32 v116, -v171, v121, v116
    v_fma_f32 v117, v171, v120, v117
    s_mov_b64 exec, -1
    ds_bpermute_b32 v118, v182, v116 offset:252
    ds_bpermute_b32 v119, v182, v117 offset:252
    s_mov_b32 exec_lo, 0xfffffffe
    s_waitcnt lgkmcnt(0)
    v_fma_f32 v116, v170, v118, v116
    v_fma_f32 v117, v170, v119, v117
    v_fma_f32 v116, -v171, v119, v116
    v_fma_f32 v117, v171, v118, v117
    s_mov_b32 exec_lo, -1
    ds_bpermute_b32 v118, v182, v116 offset:248
    ds_bpermute_b32 v119, v182, v117 offset:248
    s_mov_b32 exec_lo, 0xfffffffc
    s_waitcnt lgkmcnt(0)
    v_fma_f32 v116, v172, v118, v116
    v_fma_f32 v117, v172, v119, v117
    v_fma_f32 v116, -v173, v119, v116
    v_fma_f32 v117, v173, v118, v117
    s_mov_b32 exec_lo, -1
    ds_bpermute_b32 v118, v182, v116 offset:240
    ds_bpermute_b32 v119, v182, v117 offset:240
    s_mov_b32 exec_lo, 0xfffffff0
    s_waitcnt lgkmcnt(0)
    v_fma_f32 v116, v174, v118, v116
    v_fma_f32 v117, v174, v119, v117
    v_fma_f32 v116, -v175, v119, v116
    v_fma_f32 v117, v175, v118, v117
    s_mov_b32 exec_lo, -1
    ds_bpermute_b32 v118, v182, v116 offset:224
    ds_bpermute_b32 v119, v182, v117 offset:224
    s_mov_b32 exec_lo, 0xffffff00
    s_waitcnt lgkmcnt(0)
    v_fma_f32 v116, v176, v118, v116
    v_fma_f32 v117, v176, v119, v117
    v_fma_f32 v116, -v177, v119, v116
    v_fma_f32 v117, v177, v118, v117
    s_mov_b32 exec_lo, -1
    ds_bpermute_b32 v118, v182, v116 offset:192
    ds_bpermute_b32 v119, v182, v117 offset:192
    s_mov_b32 exec_lo, 0xffff0000
    s_waitcnt lgkmcnt(0)
    v_fma_f32 v116, v178, v118, v116
    v_fma_f32 v117, v178, v119, v117
    v_fma_f32 v116, -v179, v119, v116
    v_fma_f32 v117, v179, v118, v117
    s_mov_b32 exec_lo, -1
    ds_bpermute_b32 v118, v182, v116 offset:128
    ds_bpermute_b32 v119, v182, v117 offset:128
    s_mov_b32 exec_lo, 0x0
    s_waitcnt lgkmcnt(0)
    v_fma_f32 v116, v180, v118, v116
    v_fma_f32 v117, v180, v119, v117
    v_fma_f32 v116, -v181, v119, v116
    v_fma_f32 v117, v181, v118, v117
    s_mov_b32 exec_lo, -1
    s_cmp_eq_u32 s65, 0
    s_cbranch_scc0 L_h_nocw
    s_mov_b32 exec_lo, 0
    s_mov_b32 exec_hi, 0x80000000
    v_mov_b32 v118, 1
    ds_write_b128 v22, v[116:119]
    s_mov_b64 exec, -1
L_h_nocw:
    ds_bpermute_b32 v118, v182, v117 offset:252
    ds_bpermute_b32 v116, v182, v116 offset:252
    s_waitcnt lgkmcnt(0)
    s_mov_b64 exec, 1
    v_mov_b32 v116, v120
    v_mov_b32 v118, v121
    s_mov_b64 exec, -1
    v_fma_f32 v117, v168, v116, v112
    v_fma_f32 v119, v168, v118, v114
    v_fma_f32 v117, -v169, v118, v117
    v_fma_f32 v119, v169, v116, v119
    v_pk_fma_f32 v[80:81], v[160:161], v[116:117], v[80:81]
    v_pk_fma_f32 v[96:97], v[160:161], v[118:119], v[96:97]
    v_pk_fma_f32 v[80:81], v[162:163], v[118:119], v[80:81] neg_lo:[1,0,0] neg_hi:[1,0,0]
    v_pk_fma_f32 v[96:97], v[162:163], v[116:117], v[96:97]
    v_cvt_pk_bf16_f32 v64, v80, v81
    v_cvt_pk_bf16_f32 v72, v96, v97
    v_pk_fma_f32 v[82:83], v[160:161], v[80:81], v[82:83]
    v_pk_fma_f32 v[98:99], v[160:161], v[96:97], v[98:99]
    v_pk_fma_f32 v[82:83], v[162:163], v[96:97], v[82:83] neg_lo:[1,0,0] neg_hi:[1,0,0]
    v_pk_fma_f32 v[98:99], v[162:163], v[80:81], v[98:99]
    v_cvt_pk_bf16_f32 v65, v82, v83
    v_cvt_pk_bf16_f32 v73, v98, v99
    v_pk_fma_f32 v[84:85], v[160:161], v[82:83], v[84:85]
    v_pk_fma_f32 v[100:101], v[160:161], v[98:99], v[100:101]
    v_pk_fma_f32 v[84:85], v[162:163], v[98:99], v[84:85] neg_lo:[1,0,0] neg_hi:[1,0,0]
    v_pk_fma_f32 v[100:101], v[162:163], v[82:83], v[100:101]
    v_cvt_pk_bf16_f32 v66, v84, v85
    v_cvt_pk_bf16_f32 v74, v100, v101
    v_pk_fma_f32 v[86:87], v[160:161], v[84:85], v[86:87]
    v_pk_fma_f32 v[102:103], v[160:161], v[100:101], v[102:103]
    v_pk_fma_f32 v[86:87], v[162:163], v[100:101], v[86:87] neg_lo:[1,0,0] neg_hi:[1,0,0]
    v_pk_fma_f32 v[102:103], v[162:163], v[84:85], v[102:103]
    v_cvt_pk_bf16_f32 v67, v86, v87
    v_cvt_pk_bf16_f32 v75, v102, v103
    v_pk_fma_f32 v[88:89], v[160:161], v[86:87], v[88:89]
    v_pk_fma_f32 v[104:105], v[160:161], v[102:103], v[104:105]
    v_pk_fma_f32 v[88:89], v[162:163], v[102:103], v[88:89] neg_lo:[1,0,0] neg_hi:[1,0,0]
    v_pk_fma_f32 v[104:105], v[162:163], v[86:87], v[104:105]
    v_cvt_pk_bf16_f32 v68, v88, v89
    v_cvt_pk_bf16_f32 v76, v104, v105
    v_pk_fma_f32 v[90:91], v[160:161], v[88:89], v[90:91]
    v_pk_fma_f32 v[106:107], v[160:161], v[104:105], v[106:107]
    v_pk_fma_f32 v[90:91], v[162:163], v[104:105], v[90:91] neg_lo:[1,0,0] neg_hi:[1,0,0]
    v_pk_fma_f32 v[106:107], v[162:163], v[88:89], v[106:107]
    v_cvt_pk_bf16_f32 v69, v90, v91
    v_cvt_pk_bf16_f32 v77, v106, v107
    v_pk_fma_f32 v[92:93], v[160:161], v[90:91], v[92:93]
    v_pk_fma_f32 v[108:109], v[160:161], v[106:107], v[108:109]
    v_pk_fma_f32 v[92:93], v[162:163], v[106:107], v[92:93] neg_lo:[1,0,0] neg_hi:[1,0,0]
    v_pk_fma_f32 v[108:109], v[162:163], v[90:91], v[108:109]
    v_cvt_pk_bf16_f32 v70, v92, v93
    v_cvt_pk_bf16_f32 v78, v108, v109
    v_pk_fma_f32 v[94:95], v[160:161], v[92:93], v[94:95]
    v_pk_fma_f32 v[110:111], v[160:161], v[108:109], v[110:111]
    v_pk_fma_f32 v[94:95], v[162:163], v[108:109], v[94:95] neg_lo:[1,0,0] neg_hi:[1,0,0]
    v_pk_fma_f32 v[110:111], v[162:163], v[92:93], v[110:111]
    v_cvt_pk_bf16_f32 v71, v94, v95
    v_cvt_pk_bf16_f32 v79, v110, v111
    buffer_store_dwordx4 v[64:67], v33, s[36:39], s63 offen offset:0 sc1
    buffer_store_dwordx4 v[68:71], v33, s[36:39], s63 offen offset:1024 sc1
    buffer_store_dwordx4 v[72:75], v33, s[36:39], s64 offen offset:0 sc1
    buffer_store_dwordx4 v[76:79], v33, s[36:39], s64 offen offset:1024 sc1
    s_waitcnt vmcnt(0)
    s_mov_b64 exec, 1
    v_mov_b32 v40, 163752
    v_mov_b32 v41, 1
    ds_add_rtn_u32 v41, v40, v41
    s_waitcnt lgkmcnt(0)
    v_readfirstlane_b32 s62, v41
    s_mov_b64 exec, -1
    s_cmp_eq_u32 s62, 3
    s_cbranch_scc0 L_h_scand
    v_lshlrev_b32 v42, 7, v1
    v_mov_b32 v43, s94
    s_mov_b32 exec_lo, 0x1
    s_mov_b32 exec_hi, 0x0
    buffer_store_dword v43, v42, s[36:39], s60 offen sc1
    s_mov_b64 exec, -1
    s_branch L_h_scand
L_h_whole:
    s_add_u32 s62, s61, 2359296
    buffer_load_dwordx4 v[124:127], v39, s[36:39], s62 offen sc1
    s_add_u32 s62, s61, 2368512
    buffer_load_dwordx4 v[128:131], v39, s[36:39], s62 offen sc1
    s_add_u32 s62, s61, 2396160
    buffer_load_dwordx4 v[132:135], v39, s[36:39], s62 offen sc1
    s_add_u32 s62, s61, 2405376
    buffer_load_dwordx4 v[136:139], v39, s[36:39], s62 offen sc1
    s_waitcnt vmcnt(0)
    v_lshlrev_b32 v112, 16, v64
    v_and_b32 v113, 0xffff0000, v64
    v_lshlrev_b32 v114, 16, v72
    v_and_b32 v115, 0xffff0000, v72
    v_pk_mul_f32 v[80:81], v[164:165], v[112:113]
    v_pk_mul_f32 v[96:97], v[164:165], v[114:115] neg_lo:[1,0] neg_hi:[1,0]
    v_pk_fma_f32 v[80:81], v[166:167], v[114:115], v[80:81] neg_lo:[1,0,0] neg_hi:[1,0,0]
    v_pk_fma_f32 v[96:97], v[166:167], v[112:113], v[96:97] neg_lo:[1,0,0] neg_hi:[1,0,0]
    v_lshlrev_b32 v200, 16, v124
    v_and_b32 v201, 0xffff0000, v124
    v_lshlrev_b32 v202, 16, v132
    v_and_b32 v203, 0xffff0000, v132
    v_pk_mul_f32 v[140:141], v[164:165], v[200:201]
    v_pk_mul_f32 v[184:185], v[164:165], v[202:203] neg_lo:[1,0] neg_hi:[1,0]
    v_pk_fma_f32 v[140:141], v[166:167], v[202:203], v[140:141] neg_lo:[1,0,0] neg_hi:[1,0,0]
    v_pk_fma_f32 v[184:185], v[166:167], v[200:201], v[184:185] neg_lo:[1,0,0] neg_hi:[1,0,0]
    v_lshlrev_b32 v112, 16, v65
    v_and_b32 v113, 0xffff0000, v65
    v_lshlrev_b32 v114, 16, v73
    v_and_b32 v115, 0xffff0000, v73
    v_pk_mul_f32 v[82:83], v[164:165], v[112:113]
    v_pk_mul_f32 v[98:99], v[164:165], v[114:115] neg_lo:[1,0] neg_hi:[1,0]
    v_pk_fma_f32 v[82:83], v[166:167], v[114:115], v[82:83] neg_lo:[1,0,0] neg_hi:[1,0,0]
    v_pk_fma_f32 v[98:99], v[166:167], v[112:113], v[98:99] neg_lo:[1,0,0] neg_hi:[1,0,0]
    v_lshlrev_b32 v200, 16, v125
    v_and_b32 v201, 0xffff0000, v125
    v_lshlrev_b32 v202, 16, v133
    v_and_b32 v203, 0xffff0000, v133
    v_pk_mul_f32 v[142:143], v[164:165], v[200:201]
    v_pk_mul_f32 v[186:187], v[164:165], v[202:203] neg_lo:[1,0] neg_hi:[1,0]
    v_pk_fma_f32 v[142:143], v[166:167], v[202:203], v[142:143] neg_lo:[1,0,0] neg_hi:[1,0,0]
    v_pk_fma_f32 v[186:187], v[166:167], v[200:201], v[186:187] neg_lo:[1,0,0] neg_hi:[1,0,0]
    v_lshlrev_b32 v112, 16, v66
    v_and_b32 v113, 0xffff0000, v66
    v_lshlrev_b32 v114, 16, v74
    v_and_b32 v115, 0xffff0000, v74
    v_pk_mul_f32 v[84:85], v[164:165], v[112:113]
    v_pk_mul_f32 v[100:101], v[164:165], v[114:115] neg_lo:[1,0] neg_hi:[1,0]
    v_pk_fma_f32 v[84:85], v[166:167], v[114:115], v[84:85] neg_lo:[1,0,0] neg_hi:[1,0,0]
    v_pk_fma_f32 v[100:101], v[166:167], v[112:113], v[100:101] neg_lo:[1,0,0] neg_hi:[1,0,0]
    v_lshlrev_b32 v200, 16, v126
    v_and_b32 v201, 0xffff0000, v126
    v_lshlrev_b32 v202, 16, v134
    v_and_b32 v203, 0xffff0000, v134
    v_pk_mul_f32 v[144:145], v[164:165], v[200:201]
    v_pk_mul_f32 v[188:189], v[164:165], v[202:203] neg_lo:[1,0] neg_hi:[1,0]
    v_pk_fma_f32 v[144:145], v[166:167], v[202:203], v[144:145] neg_lo:[1,0,0] neg_hi:[1,0,0]
    v_pk_fma_f32 v[188:189], v[166:167], v[200:201], v[188:189] neg_lo:[1,0,0] neg_hi:[1,0,0]
    v_lshlrev_b32 v112, 16, v67
    v_and_b32 v113, 0xffff0000, v67
    v_lshlrev_b32 v114, 16, v75
    v_and_b32 v115, 0xffff0000, v75
    v_pk_mul_f32 v[86:87], v[164:165], v[112:113]
    v_pk_mul_f32 v[102:103], v[164:165], v[114:115] neg_lo:[1,0] neg_hi:[1,0]
    v_pk_fma_f32 v[86:87], v[166:167], v[114:115], v[86:87] neg_lo:[1,0,0] neg_hi:[1,0,0]
    v_pk_fma_f32 v[102:103], v[166:167], v[112:113], v[102:103] neg_lo:[1,0,0] neg_hi:[1,0,0]
    v_lshlrev_b32 v200, 16, v127
    v_and_b32 v201, 0xffff0000, v127
    v_lshlrev_b32 v202, 16, v135
    v_and_b32 v203, 0xffff0000, v135
    v_pk_mul_f32 v[146:147], v[164:165], v[200:201]
    v_pk_mul_f32 v[190:191], v[164:165], v[202:203] neg_lo:[1,0] neg_hi:[1,0]
    v_pk_fma_f32 v[146:147], v[166:167], v[202:203], v[146:147] neg_lo:[1,0,0] neg_hi:[1,0,0]
    v_pk_fma_f32 v[190:191], v[166:167], v[200:201], v[190:191] neg_lo:[1,0,0] neg_hi:[1,0,0]
    v_lshlrev_b32 v112, 16, v68
    v_and_b32 v113, 0xffff0000, v68
    v_lshlrev_b32 v114, 16, v76
    v_and_b32 v115, 0xffff0000, v76
    v_pk_mul_f32 v[88:89], v[164:165], v[112:113]
    v_pk_mul_f32 v[104:105], v[164:165], v[114:115] neg_lo:[1,0] neg_hi:[1,0]
    v_pk_fma_f32 v[88:89], v[166:167], v[114:115], v[88:89] neg_lo:[1,0,0] neg_hi:[1,0,0]
    v_pk_fma_f32 v[104:105], v[166:167], v[112:113], v[104:105] neg_lo:[1,0,0] neg_hi:[1,0,0]
    v_lshlrev_b32 v200, 16, v128
    v_and_b32 v201, 0xffff0000, v128
    v_lshlrev_b32 v202, 16, v136
    v_and_b32 v203, 0xffff0000, v136
    v_pk_mul_f32 v[148:149], v[164:165], v[200:201]
    v_pk_mul_f32 v[192:193], v[164:165], v[202:203] neg_lo:[1,0] neg_hi:[1,0]
    v_pk_fma_f32 v[148:149], v[166:167], v[202:203], v[148:149] neg_lo:[1,0,0] neg_hi:[1,0,0]
    v_pk_fma_f32 v[192:193], v[166:167], v[200:201], v[192:193] neg_lo:[1,0,0] neg_hi:[1,0,0]
    v_lshlrev_b32 v112, 16, v69
    v_and_b32 v113, 0xffff0000, v69
    v_lshlrev_b32 v114, 16, v77
    v_and_b32 v115, 0xffff0000, v77
    v_pk_mul_f32 v[90:91], v[164:165], v[112:113]
    v_pk_mul_f32 v[106:107], v[164:165], v[114:115] neg_lo:[1,0] neg_hi:[1,0]
    v_pk_fma_f32 v[90:91], v[166:167], v[114:115], v[90:91] neg_lo:[1,0,0] neg_hi:[1,0,0]
    v_pk_fma_f32 v[106:107], v[166:167], v[112:113], v[106:107] neg_lo:[1,0,0] neg_hi:[1,0,0]
    v_lshlrev_b32 v200, 16, v129
    v_and_b32 v201, 0xffff0000, v129
    v_lshlrev_b32 v202, 16, v137
    v_and_b32 v203, 0xffff0000, v137
    v_pk_mul_f32 v[150:151], v[164:165], v[200:201]
    v_pk_mul_f32 v[194:195], v[164:165], v[202:203] neg_lo:[1,0] neg_hi:[1,0]
    v_pk_fma_f32 v[150:151], v[166:167], v[202:203], v[150:151] neg_lo:[1,0,0] neg_hi:[1,0,0]
    v_pk_fma_f32 v[194:195], v[166:167], v[200:201], v[194:195] neg_lo:[1,0,0] neg_hi:[1,0,0]
    v_lshlrev_b32 v112, 16, v70
    v_and_b32 v113, 0xffff0000, v70
    v_lshlrev_b32 v114, 16, v78
    v_and_b32 v115, 0xffff0000, v78
    v_pk_mul_f32 v[92:93], v[164:165], v[112:113]
    v_pk_mul_f32 v[108:109], v[164:165], v[114:115] neg_lo:[1,0] neg_hi:[1,0]
    v_pk_fma_f32 v[92:93], v[166:167], v[114:115], v[92:93] neg_lo:[1,0,0] neg_hi:[1,0,0]
    v_pk_fma_f32 v[108:109], v[166:167], v[112:113], v[108:109] neg_lo:[1,0,0] neg_hi:[1,0,0]
    v_lshlrev_b32 v200, 16, v130
    v_and_b32 v201, 0xffff0000, v130
    v_lshlrev_b32 v202, 16, v138
    v_and_b32 v203, 0xffff0000, v138
    v_pk_mul_f32 v[152:153], v[164:165], v[200:201]
    v_pk_mul_f32 v[196:197], v[164:165], v[202:203] neg_lo:[1,0] neg_hi:[1,0]
    v_pk_fma_f32 v[152:153], v[166:167], v[202:203], v[152:153] neg_lo:[1,0,0] neg_hi:[1,0,0]
    v_pk_fma_f32 v[196:197], v[166:167], v[200:201], v[196:197] neg_lo:[1,0,0] neg_hi:[1,0,0]
    v_lshlrev_b32 v112, 16, v71
    v_and_b32 v113, 0xffff0000, v71
    v_lshlrev_b32 v114, 16, v79
    v_and_b32 v115, 0xffff0000, v79
    v_pk_mul_f32 v[94:95], v[164:165], v[112:113]
    v_pk_mul_f32 v[110:111], v[164:165], v[114:115] neg_lo:[1,0] neg_hi:[1,0]
    v_pk_fma_f32 v[94:95], v[166:167], v[114:115], v[94:95] neg_lo:[1,0,0] neg_hi:[1,0,0]
    v_pk_fma_f32 v[110:111], v[166:167], v[112:113], v[110:111] neg_lo:[1,0,0] neg_hi:[1,0,0]
    v_lshlrev_b32 v200, 16, v131
    v_and_b32 v201, 0xffff0000, v131
    v_lshlrev_b32 v202, 16, v139
    v_and_b32 v203, 0xffff0000, v139
    v_pk_mul_f32 v[154:155], v[164:165], v[200:201]
    v_pk_mul_f32 v[198:199], v[164:165], v[202:203] neg_lo:[1,0] neg_hi:[1,0]
    v_pk_fma_f32 v[154:155], v[166:167], v[202:203], v[154:155] neg_lo:[1,0,0] neg_hi:[1,0,0]
    v_pk_fma_f32 v[198:199], v[166:167], v[200:201], v[198:199] neg_lo:[1,0,0] neg_hi:[1,0,0]
    v_pk_fma_f32 v[112:113], v[160:161], v[80:81], v[82:83]
    v_pk_fma_f32 v[200:201], v[160:161], v[140:141], v[142:143]
    v_pk_fma_f32 v[114:115], v[160:161], v[96:97], v[98:99]
    v_pk_fma_f32 v[202:203], v[160:161], v[184:185], v[186:187]
    v_pk_fma_f32 v[112:113], v[162:163], v[96:97], v[112:113] neg_lo:[1,0,0] neg_hi:[1,0,0]
    v_pk_fma_f32 v[200:201], v[162:163], v[184:185], v[200:201] neg_lo:[1,0,0] neg_hi:[1,0,0]
    v_pk_fma_f32 v[114:115], v[162:163], v[80:81], v[114:115]
    v_pk_fma_f32 v[202:203], v[162:163], v[140:141], v[202:203]
    v_pk_fma_f32 v[116:117], v[160:161], v[112:113], v[84:85]
    v_pk_fma_f32 v[204:205], v[160:161], v[200:201], v[144:145]
    v_pk_fma_f32 v[118:119], v[160:161], v[114:115], v[100:101]
    v_pk_fma_f32 v[206:207], v[160:161], v[202:203], v[188:189]
    v_pk_fma_f32 v[116:117], v[162:163], v[114:115], v[116:117] neg_lo:[1,0,0] neg_hi:[1,0,0]
    v_pk_fma_f32 v[204:205], v[162:163], v[202:203], v[204:205] neg_lo:[1,0,0] neg_hi:[1,0,0]
    v_pk_fma_f32 v[118:119], v[162:163], v[112:113], v[118:119]
    v_pk_fma_f32 v[206:207], v[162:163], v[200:201], v[206:207]
    v_pk_fma_f32 v[112:113], v[160:161], v[116:117], v[86:87]
    v_pk_fma_f32 v[200:201], v[160:161], v[204:205], v[146:147]
    v_pk_fma_f32 v[114:115], v[160:161], v[118:119], v[102:103]
    v_pk_fma_f32 v[202:203], v[160:161], v[206:207], v[190:191]
    v_pk_fma_f32 v[112:113], v[162:163], v[118:119], v[112:113] neg_lo:[1,0,0] neg_hi:[1,0,0]
    v_pk_fma_f32 v[200:201], v[162:163], v[206:207], v[200:201] neg_lo:[1,0,0] neg_hi:[1,0,0]
    v_pk_fma_f32 v[114:115], v[162:163], v[116:117], v[114:115]
    v_pk_fma_f32 v[202:203], v[162:163], v[204:205], v[202:203]
    v_pk_fma_f32 v[116:117], v[160:161], v[112:113], v[88:89]
    v_pk_fma_f32 v[204:205], v[160:161], v[200:201], v[148:149]
    v_pk_fma_f32 v[118:119], v[160:161], v[114:115], v[104:105]
    v_pk_fma_f32 v[206:207], v[160:161], v[202:203], v[192:193]
    v_pk_fma_f32 v[116:117], v[162:163], v[114:115], v[116:117] neg_lo:[1,0,0] neg_hi:[1,0,0]
    v_pk_fma_f32 v[204:205], v[162:163], v[202:203], v[204:205] neg_lo:[1,0,0] neg_hi:[1,0,0]
    v_pk_fma_f32 v[118:119], v[162:163], v[112:113], v[118:119]
    v_pk_fma_f32 v[206:207], v[162:163], v[200:201], v[206:207]
    v_pk_fma_f32 v[112:113], v[160:161], v[116:117], v[90:91]
    v_pk_fma_f32 v[200:201], v[160:161], v[204:205], v[150:151]
    v_pk_fma_f32 v[114:115], v[160:161], v[118:119], v[106:107]
    v_pk_fma_f32 v[202:203], v[160:161], v[206:207], v[194:195]
    v_pk_fma_f32 v[112:113], v[162:163], v[118:119], v[112:113] neg_lo:[1,0,0] neg_hi:[1,0,0]
    v_pk_fma_f32 v[200:201], v[162:163], v[206:207], v[200:201] neg_lo:[1,0,0] neg_hi:[1,0,0]
    v_pk_fma_f32 v[114:115], v[162:163], v[116:117], v[114:115]
    v_pk_fma_f32 v[202:203], v[162:163], v[204:205], v[202:203]
    v_pk_fma_f32 v[116:117], v[160:161], v[112:113], v[92:93]
    v_pk_fma_f32 v[204:205], v[160:161], v[200:201], v[152:153]
    v_pk_fma_f32 v[118:119], v[160:161], v[114:115], v[108:109]
    v_pk_fma_f32 v[206:207], v[160:161], v[202:203], v[196:197]
    v_pk_fma_f32 v[116:117], v[162:163], v[114:115], v[116:117] neg_lo:[1,0,0] neg_hi:[1,0,0]
    v_pk_fma_f32 v[204:205], v[162:163], v[202:203], v[204:205] neg_lo:[1,0,0] neg_hi:[1,0,0]
    v_pk_fma_f32 v[118:119], v[162:163], v[112:113], v[118:119]
    v_pk_fma_f32 v[206:207], v[162:163], v[200:201], v[206:207]
    v_pk_fma_f32 v[112:113], v[160:161], v[116:117], v[94:95]
    v_pk_fma_f32 v[200:201], v[160:161], v[204:205], v[154:155]
    v_pk_fma_f32 v[114:115], v[160:161], v[118:119], v[110:111]
    v_pk_fma_f32 v[202:203], v[160:161], v[206:207], v[198:199]
    v_pk_fma_f32 v[112:113], v[162:163], v[118:119], v[112:113] neg_lo:[1,0,0] neg_hi:[1,0,0]
    v_pk_fma_f32 v[200:201], v[162:163], v[206:207], v[200:201] neg_lo:[1,0,0] neg_hi:[1,0,0]
    v_pk_fma_f32 v[114:115], v[162:163], v[116:117], v[114:115]
    v_pk_fma_f32 v[202:203], v[162:163], v[204:205], v[202:203]
    v_fma_f32 v116, v168, v112, v113
    v_fma_f32 v117, v168, v114, v115
    v_fma_f32 v116, -v169, v114, v116
    v_fma_f32 v117, v169, v112, v117
    v_fma_f32 v204, v168, v200, v201
    v_fma_f32 v205, v168, v202, v203
    v_fma_f32 v204, -v169, v202, v204
    v_fma_f32 v205, v169, v200, v205
    s_mov_b64 exec, 1
    v_fma_f32 v116, v170, v120, v116
    v_fma_f32 v117, v170, v121, v117
    v_fma_f32 v116, -v171, v121, v116
    v_fma_f32 v117, v171, v120, v117
    s_mov_b64 exec, -1
    ds_bpermute_b32 v118, v182, v116 offset:252
    ds_bpermute_b32 v119, v182, v117 offset:252
    s_mov_b32 exec_lo, 0xfffffffe
    s_waitcnt lgkmcnt(0)
    v_fma_f32 v116, v170, v118, v116
    v_fma_f32 v117, v170, v119, v117
    v_fma_f32 v116, -v171, v119, v116
    v_fma_f32 v117, v171, v118, v117
    s_mov_b32 exec_lo, -1
    ds_bpermute_b32 v118, v182, v116 offset:248
    ds_bpermute_b32 v119, v182, v117 offset:248
    s_mov_b32 exec_lo, 0xfffffffc
    s_waitcnt lgkmcnt(0)
    v_fma_f32 v116, v172, v118, v116
    v_fma_f32 v117, v172, v119, v117
    v_fma_f32 v116, -v173, v119, v116
    v_fma_f32 v117, v173, v118, v117
    s_mov_b32 exec_lo, -1
    ds_bpermute_b32 v118, v182, v116 offset:240
    ds_bpermute_b32 v119, v182, v117 offset:240
    s_mov_b32 exec_lo, 0xfffffff0
    s_waitcnt lgkmcnt(0)
    v_fma_f32 v116, v174, v118, v116
    v_fma_f32 v117, v174, v119, v117
    v_fma_f32 v116, -v175, v119, v116
    v_fma_f32 v117, v175, v118, v117
    s_mov_b32 exec_lo, -1
    ds_bpermute_b32 v118, v182, v116 offset:224
    ds_bpermute_b32 v119, v182, v117 offset:224
    s_mov_b32 exec_lo, 0xffffff00
    s_waitcnt lgkmcnt(0)
    v_fma_f32 v116, v176, v118, v116
    v_fma_f32 v117, v176, v119, v117
    v_fma_f32 v116, -v177, v119, v116
    v_fma_f32 v117, v177, v118, v117
    s_mov_b32 exec_lo, -1
    ds_bpermute_b32 v118, v182, v116 offset:192
    ds_bpermute_b32 v119, v182, v117 offset:192
    s_mov_b32 exec_lo, 0xffff0000
    s_waitcnt lgkmcnt(0)
    v_fma_f32 v116, v178, v118, v116
    v_fma_f32 v117, v178, v119, v117
    v_fma_f32 v116, -v179, v119, v116
    v_fma_f32 v117, v179, v118, v117
    s_mov_b32 exec_lo, -1
    ds_bpermute_b32 v118, v182, v116 offset:128
    ds_bpermute_b32 v119, v182, v117 offset:128
    s_mov_b32 exec_lo, 0x0
    s_waitcnt lgkmcnt(0)
    v_fma_f32 v116, v180, v118, v116
    v_fma_f32 v117, v180, v119, v117
    v_fma_f32 v116, -v181, v119, v116
    v_fma_f32 v117, v181, v118, v117
    s_mov_b32 exec_lo, -1
    s_nop 0
    v_readlane_b32 s66, v116, 63
    v_readlane_b32 s67, v117, 63
    s_nop 1
    v_mov_b32 v208, s66
    v_mov_b32 v209, s67
    s_mov_b64 exec, 1
    v_fma_f32 v204, v170, v208, v204
    v_fma_f32 v205, v170, v209, v205
    v_fma_f32 v204, -v171, v209, v204
    v_fma_f32 v205, v171, v208, v205
    s_mov_b64 exec, -1
    ds_bpermute_b32 v206, v182, v204 offset:252
    ds_bpermute_b32 v207, v182, v205 offset:252
    s_mov_b32 exec_lo, 0xfffffffe
    s_waitcnt lgkmcnt(0)
    v_fma_f32 v204, v170, v206, v204
    v_fma_f32 v205, v170, v207, v205
    v_fma_f32 v204, -v171, v207, v204
    v_fma_f32 v205, v171, v206, v205
    s_mov_b32 exec_lo, -1
    ds_bpermute_b32 v206, v182, v204 offset:248
    ds_bpermute_b32 v207, v182, v205 offset:248
    s_mov_b32 exec_lo, 0xfffffffc
    s_waitcnt lgkmcnt(0)
    v_fma_f32 v204, v172, v206, v204
    v_fma_f32 v205, v172, v207, v205
    v_fma_f32 v204, -v173, v207, v204
    v_fma_f32 v205, v173, v206, v205
    s_mov_b32 exec_lo, -1
    ds_bpermute_b32 v206, v182, v204 offset:240
    ds_bpermute_b32 v207, v182, v205 offset:240
    s_mov_b32 exec_lo, 0xfffffff0
    s_waitcnt lgkmcnt(0)
    v_fma_f32 v204, v174, v206, v204
    v_fma_f32 v205, v174, v207, v205
    v_fma_f32 v204, -v175, v207, v204
    v_fma_f32 v205, v175, v206, v205
    s_mov_b32 exec_lo, -1
    ds_bpermute_b32 v206, v182, v204 offset:224
    ds_bpermute_b32 v207, v182, v205 offset:224
    s_mov_b32 exec_lo, 0xffffff00
    s_waitcnt lgkmcnt(0)
    v_fma_f32 v204, v176, v206, v204
    v_fma_f32 v205, v176, v207, v205
    v_fma_f32 v204, -v177, v207, v204
    v_fma_f32 v205, v177, v206, v205
    s_mov_b32 exec_lo, -1
    ds_bpermute_b32 v206, v182, v204 offset:192
    ds_bpermute_b32 v207, v182, v205 offset:192
    s_mov_b32 exec_lo, 0xffff0000
    s_waitcnt lgkmcnt(0)
    v_fma_f32 v204, v178, v206, v204
    v_fma_f32 v205, v178, v207, v205
    v_fma_f32 v204, -v179, v207, v204
    v_fma_f32 v205, v179, v206, v205
    s_mov_b32 exec_lo, -1
    ds_bpermute_b32 v206, v182, v204 offset:128
    ds_bpermute_b32 v207, v182, v205 offset:128
    s_mov_b32 exec_lo, 0x0
    s_waitcnt lgkmcnt(0)
    v_fma_f32 v204, v180, v206, v204
    v_fma_f32 v205, v180, v207, v205
    v_fma_f32 v204, -v181, v207, v204
    v_fma_f32 v205, v181, v206, v205
    s_mov_b32 exec_lo, -1
    ds_bpermute_b32 v118, v182, v117 offset:252
    ds_bpermute_b32 v116, v182, v116 offset:252
    s_waitcnt lgkmcnt(0)
    s_mov_b64 exec, 1
    v_mov_b32 v116, v120
    v_mov_b32 v118, v121
    s_mov_b64 exec, -1
    v_fma_f32 v117, v168, v116, v112
    v_fma_f32 v119, v168, v118, v114
    v_fma_f32 v117, -v169, v118, v117
    v_fma_f32 v119, v169, v116, v119
    ds_bpermute_b32 v206, v182, v205 offset:252
    ds_bpermute_b32 v204, v182, v204 offset:252
    s_waitcnt lgkmcnt(0)
    s_mov_b64 exec, 1
    v_mov_b32 v204, v208
    v_mov_b32 v206, v209
    s_mov_b64 exec, -1
    v_fma_f32 v205, v168, v204, v200
    v_fma_f32 v207, v168, v206, v202
    v_fma_f32 v205, -v169, v206, v205
    v_fma_f32 v207, v169, v204, v207
    v_pk_fma_f32 v[80:81], v[160:161], v[116:117], v[80:81]
    v_pk_fma_f32 v[140:141], v[160:161], v[204:205], v[140:141]
    v_pk_fma_f32 v[96:97], v[160:161], v[118:119], v[96:97]
    v_pk_fma_f32 v[184:185], v[160:161], v[206:207], v[184:185]
    v_pk_fma_f32 v[80:81], v[162:163], v[118:119], v[80:81] neg_lo:[1,0,0] neg_hi:[1,0,0]
    v_pk_fma_f32 v[140:141], v[162:163], v[206:207], v[140:141] neg_lo:[1,0,0] neg_hi:[1,0,0]
    v_pk_fma_f32 v[96:97], v[162:163], v[116:117], v[96:97]
    v_pk_fma_f32 v[184:185], v[162:163], v[204:205], v[184:185]
    v_cvt_pk_bf16_f32 v64, v80, v81
    v_cvt_pk_bf16_f32 v72, v96, v97
    v_cvt_pk_bf16_f32 v124, v140, v141
    v_cvt_pk_bf16_f32 v132, v184, v185
    v_pk_fma_f32 v[82:83], v[160:161], v[80:81], v[82:83]
    v_pk_fma_f32 v[142:143], v[160:161], v[140:141], v[142:143]
    v_pk_fma_f32 v[98:99], v[160:161], v[96:97], v[98:99]
    v_pk_fma_f32 v[186:187], v[160:161], v[184:185], v[186:187]
    v_pk_fma_f32 v[82:83], v[162:163], v[96:97], v[82:83] neg_lo:[1,0,0] neg_hi:[1,0,0]
    v_pk_fma_f32 v[142:143], v[162:163], v[184:185], v[142:143] neg_lo:[1,0,0] neg_hi:[1,0,0]
    v_pk_fma_f32 v[98:99], v[162:163], v[80:81], v[98:99]
    v_pk_fma_f32 v[186:187], v[162:163], v[140:141], v[186:187]
    v_cvt_pk_bf16_f32 v65, v82, v83
    v_cvt_pk_bf16_f32 v73, v98, v99
    v_cvt_pk_bf16_f32 v125, v142, v143
    v_cvt_pk_bf16_f32 v133, v186, v187
    v_pk_fma_f32 v[84:85], v[160:161], v[82:83], v[84:85]
    v_pk_fma_f32 v[144:145], v[160:161], v[142:143], v[144:145]
    v_pk_fma_f32 v[100:101], v[160:161], v[98:99], v[100:101]
    v_pk_fma_f32 v[188:189], v[160:161], v[186:187], v[188:189]
    v_pk_fma_f32 v[84:85], v[162:163], v[98:99], v[84:85] neg_lo:[1,0,0] neg_hi:[1,0,0]
    v_pk_fma_f32 v[144:145], v[162:163], v[186:187], v[144:145] neg_lo:[1,0,0] neg_hi:[1,0,0]
    v_pk_fma_f32 v[100:101], v[162:163], v[82:83], v[100:101]
    v_pk_fma_f32 v[188:189], v[162:163], v[142:143], v[188:189]
    v_cvt_pk_bf16_f32 v66, v84, v85
    v_cvt_pk_bf16_f32 v74, v100, v101
    v_cvt_pk_bf16_f32 v126, v144, v145
    v_cvt_pk_bf16_f32 v134, v188, v189
    v_pk_fma_f32 v[86:87], v[160:161], v[84:85], v[86:87]
    v_pk_fma_f32 v[146:147], v[160:161], v[144:145], v[146:147]
    v_pk_fma_f32 v[102:103], v[160:161], v[100:101], v[102:103]
    v_pk_fma_f32 v[190:191], v[160:161], v[188:189], v[190:191]
    v_pk_fma_f32 v[86:87], v[162:163], v[100:101], v[86:87] neg_lo:[1,0,0] neg_hi:[1,0,0]
    v_pk_fma_f32 v[146:147], v[162:163], v[188:189], v[146:147] neg_lo:[1,0,0] neg_hi:[1,0,0]
    v_pk_fma_f32 v[102:103], v[162:163], v[84:85], v[102:103]
    v_pk_fma_f32 v[190:191], v[162:163], v[144:145], v[190:191]
    v_cvt_pk_bf16_f32 v67, v86, v87
    v_cvt_pk_bf16_f32 v75, v102, v103
    v_cvt_pk_bf16_f32 v127, v146, v147
    v_cvt_pk_bf16_f32 v135, v190, v191
    v_pk_fma_f32 v[88:89], v[160:161], v[86:87], v[88:89]
    v_pk_fma_f32 v[148:149], v[160:161], v[146:147], v[148:149]
    v_pk_fma_f32 v[104:105], v[160:161], v[102:103], v[104:105]
    v_pk_fma_f32 v[192:193], v[160:161], v[190:191], v[192:193]
    v_pk_fma_f32 v[88:89], v[162:163], v[102:103], v[88:89] neg_lo:[1,0,0] neg_hi:[1,0,0]
    v_pk_fma_f32 v[148:149], v[162:163], v[190:191], v[148:149] neg_lo:[1,0,0] neg_hi:[1,0,0]
    v_pk_fma_f32 v[104:105], v[162:163], v[86:87], v[104:105]
    v_pk_fma_f32 v[192:193], v[162:163], v[146:147], v[192:193]
    v_cvt_pk_bf16_f32 v68, v88, v89
    v_cvt_pk_bf16_f32 v76, v104, v105
    v_cvt_pk_bf16_f32 v128, v148, v149
    v_cvt_pk_bf16_f32 v136, v192, v193
    v_pk_fma_f32 v[90:91], v[160:161], v[88:89], v[90:91]
    v_pk_fma_f32 v[150:151], v[160:161], v[148:149], v[150:151]
    v_pk_fma_f32 v[106:107], v[160:161], v[104:105], v[106:107]
    v_pk_fma_f32 v[194:195], v[160:161], v[192:193], v[194:195]
    v_pk_fma_f32 v[90:91], v[162:163], v[104:105], v[90:91] neg_lo:[1,0,0] neg_hi:[1,0,0]
    v_pk_fma_f32 v[150:151], v[162:163], v[192:193], v[150:151] neg_lo:[1,0,0] neg_hi:[1,0,0]
    v_pk_fma_f32 v[106:107], v[162:163], v[88:89], v[106:107]
    v_pk_fma_f32 v[194:195], v[162:163], v[148:149], v[194:195]
    v_cvt_pk_bf16_f32 v69, v90, v91
    v_cvt_pk_bf16_f32 v77, v106, v107
    v_cvt_pk_bf16_f32 v129, v150, v151
    v_cvt_pk_bf16_f32 v137, v194, v195
    v_pk_fma_f32 v[92:93], v[160:161], v[90:91], v[92:93]
    v_pk_fma_f32 v[152:153], v[160:161], v[150:151], v[152:153]
    v_pk_fma_f32 v[108:109], v[160:161], v[106:107], v[108:109]
    v_pk_fma_f32 v[196:197], v[160:161], v[194:195], v[196:197]
    v_pk_fma_f32 v[92:93], v[162:163], v[106:107], v[92:93] neg_lo:[1,0,0] neg_hi:[1,0,0]
    v_pk_fma_f32 v[152:153], v[162:163], v[194:195], v[152:153] neg_lo:[1,0,0] neg_hi:[1,0,0]
    v_pk_fma_f32 v[108:109], v[162:163], v[90:91], v[108:109]
    v_pk_fma_f32 v[196:197], v[162:163], v[150:151], v[196:197]
    v_cvt_pk_bf16_f32 v70, v92, v93
    v_cvt_pk_bf16_f32 v78, v108, v109
    v_cvt_pk_bf16_f32 v130, v152, v153
    v_cvt_pk_bf16_f32 v138, v196, v197
    v_pk_fma_f32 v[94:95], v[160:161], v[92:93], v[94:95]
    v_pk_fma_f32 v[154:155], v[160:161], v[152:153], v[154:155]
    v_pk_fma_f32 v[110:111], v[160:161], v[108:109], v[110:111]
    v_pk_fma_f32 v[198:199], v[160:161], v[196:197], v[198:199]
    v_pk_fma_f32 v[94:95], v[162:163], v[108:109], v[94:95] neg_lo:[1,0,0] neg_hi:[1,0,0]
    v_pk_fma_f32 v[154:155], v[162:163], v[196:197], v[154:155] neg_lo:[1,0,0] neg_hi:[1,0,0]
    v_pk_fma_f32 v[110:111], v[162:163], v[92:93], v[110:111]
    v_pk_fma_f32 v[198:199], v[162:163], v[152:153], v[198:199]
    v_cvt_pk_bf16_f32 v71, v94, v95
    v_cvt_pk_bf16_f32 v79, v110, v111
    v_cvt_pk_bf16_f32 v131, v154, v155
    v_cvt_pk_bf16_f32 v139, v198, v199
    buffer_store_dwordx4 v[64:67], v33, s[36:39], s63 offen offset:0 sc1
    buffer_store_dwordx4 v[68:71], v33, s[36:39], s63 offen offset:1024 sc1
    buffer_store_dwordx4 v[72:75], v33, s[36:39], s64 offen offset:0 sc1
    buffer_store_dwordx4 v[76:79], v33, s[36:39], s64 offen offset:1024 sc1
    buffer_store_dwordx4 v[124:127], v33, s[36:39], s63 offen offset:2048 sc1
    buffer_store_dwordx4 v[128:131], v33, s[36:39], s63 offen offset:3072 sc1
    buffer_store_dwordx4 v[132:135], v33, s[36:39], s64 offen offset:2048 sc1
    buffer_store_dwordx4 v[136:139], v33, s[36:39], s64 offen offset:3072 sc1
    s_waitcnt vmcnt(0)
    s_mov_b64 exec, 1
    v_mov_b32 v40, 163752
    v_mov_b32 v41, 1
    ds_add_rtn_u32 v41, v40, v41
    s_waitcnt lgkmcnt(0)
    v_readfirstlane_b32 s62, v41
    s_mov_b64 exec, -1
    s_cmp_eq_u32 s62, 2
    s_cbranch_scc0 L_h_scand
    v_lshlrev_b32 v42, 7, v1
    v_mov_b32 v43, s94
    s_mov_b32 exec_lo, 0x1
    s_mov_b32 exec_hi, 0x0
    buffer_store_dword v43, v42, s[36:39], s60 offen sc1
    s_mov_b64 exec, -1
L_h_scand:
    s_cmp_ge_u32 s35, 24
    s_cbranch_scc1 L_h_nop3
    s_and_b32 s58, s34, 3
    s_lshl_b32 s58, s58, 3
    s_and_b32 s59, s35, 7
    s_add_u32 s58, s58, s59
    s_lshr_b32 s59, s34, 2
    s_mul_i32 s59, s59, 3
    s_lshr_b32 s60, s35, 3
    s_add_u32 s59, s59, s60
    s_mul_i32 s57, s69, 6144
    s_add_u32 s57, s57, 16384
    s_lshr_b32 s60, s69, 1
    s_mul_i32 s60, s60, 2359296
    s_and_b32 s61, s69, 1
    s_lshl_b32 s62, s61, 17
    s_add_u32 s60, s60, s62
    s_and_b32 s62, s58, 1
    s_lshl_b32 s62, s62, 10
    s_add_u32 s60, s60, s62
    s_lshr_b32 s62, s58, 4
    s_lshl_b32 s62, s62, 11
    s_add_u32 s60, s60, s62
    s_bfe_u32 s62, s58, 0x30001
    s_lshl_b32 s62, s62, 7
    s_add_u32 s60, s60, s62
    s_add_u32 s60, s60, 14155776
    s_lshl_b32 s62, s59, 1
    s_add_u32 s61, s61, s62
    s_mul_i32 s61, s61, 55296
    s_cmp_ge_u32 s69, 2
    s_cselect_b32 s44, s22, s20
    s_cselect_b32 s45, s23, s21
    s_mov_b32 s46, 663552
    s_mov_b32 s47, 0x00020000
    s_mov_b32 s40, s32
    s_mov_b32 s41, s33
    s_mov_b32 s42, 19091456
    s_mov_b32 s43, 0x00020000
    s_mul_i32 s51, s59, 192
    s_mul_i32 s63, s69, 186624
    s_add_u32 s63, s63, s51
    s_add_u32 s64, s63, 103680
    s_cmp_eq_u32 s69, 3
    s_cselect_b32 s64, s51, s64
    s_mov_b32 s65, 20736
    s_cselect_b32 s65, 165888, s65
    s_mul_i32 s66, s69, 20480
    s_mul_i32 s62, s69, 589824
    s_lshl_b32 s67, s58, 10
    s_add_u32 s62, s62, s67
    s_add_u32 s62, s62, 7077888
    s_lshl_b32 s50, s58, 6
    s_lshl_b32 s67, s69, 4
    s_add_u32 s50, s50, s67
    s_mul_i32 s50, s50, 4608
    s_mul_i32 s67, s59, 384
    s_add_u32 s50, s50, s67
    s_mov_b32 s52, s8
    s_mov_b32 s53, s9
    s_mov_b32 s54, 663552
    s_mov_b32 s55, 0x00020000
    s_setprio 0
    v_and_b32 v10, 3, v1
    v_lshlrev_b32 v10, 2, v10
    v_add_u32 v10, 163808, v10
L_pw_19:
    ds_read_b32 v11, v10
    s_waitcnt lgkmcnt(0)
    v_cmp_le_u32 vcc, 81920, v11
    s_cmp_eq_u64 vcc, exec
    s_cbranch_scc1 L_pwd_20
    s_sleep 4
    s_branch L_pw_19
L_pwd_20:
    s_add_u32 s49, s63, 0
    s_add_u32 m0, s66, 0
    s_nop 0
    buffer_load_dwordx4 v242, s[52:55], s49 offen lds
    s_add_u32 m0, s66, 1024
    s_nop 0
    buffer_load_dwordx4 v243, s[52:55], s49 offen lds
    s_add_u32 m0, s66, 2048
    s_nop 0
    buffer_load_dwordx4 v244, s[52:55], s49 offen lds
    s_add_u32 s49, s63, 20736
    s_add_u32 m0, s66, 3072
    s_nop 0
    buffer_load_dwordx4 v242, s[52:55], s49 offen lds
    s_add_u32 m0, s66, 4096
    s_nop 0
    buffer_load_dwordx4 v243, s[52:55], s49 offen lds
    s_add_u32 m0, s66, 5120
    s_nop 0
    buffer_load_dwordx4 v244, s[52:55], s49 offen lds
    s_add_u32 s49, s63, 41472
    s_add_u32 m0, s66, 6144
    s_nop 0
    buffer_load_dwordx4 v242, s[52:55], s49 offen lds
    s_add_u32 m0, s66, 7168
    s_nop 0
    buffer_load_dwordx4 v243, s[52:55], s49 offen lds
    s_add_u32 m0, s66, 8192
    s_nop 0
    buffer_load_dwordx4 v244, s[52:55], s49 offen lds
    s_add_u32 s49, s63, 62208
    s_add_u32 m0, s66, 9216
    s_nop 0
    buffer_load_dwordx4 v242, s[52:55], s49 offen lds
    s_add_u32 m0, s66, 10240
    s_nop 0
    buffer_load_dwordx4 v243, s[52:55], s49 offen lds
    s_add_u32 m0, s66, 11264
    s_nop 0
    buffer_load_dwordx4 v244, s[52:55], s49 offen lds
    s_add_u32 s49, s63, 82944
    s_add_u32 m0, s66, 12288
    s_nop 0
    buffer_load_dwordx4 v242, s[52:55], s49 offen lds
    s_add_u32 m0, s66, 13312
    s_nop 0
    buffer_load_dwordx4 v243, s[52:55], s49 offen lds
    s_add_u32 m0, s66, 14336
    s_nop 0
    buffer_load_dwordx4 v244, s[52:55], s49 offen lds
    s_mov_b32 s49, s64
    s_add_u32 m0, s66, 15360
    s_nop 0
    buffer_load_dwordx4 v245, s[52:55], s49 offen lds
    s_add_u32 m0, s66, 16384
    s_nop 0
    buffer_load_dwordx4 v246, s[52:55], s49 offen lds
    s_add_u32 m0, s66, 17408
    s_nop 0
    buffer_load_dwordx4 v247, s[52:55], s49 offen lds
    s_waitcnt vmcnt(0)
    ds_read_b64_tr_b16 v[16:17], v240 offset:0
    ds_read_b64_tr_b16 v[18:19], v240 offset:768
    ds_read_b64_tr_b16 v[20:21], v240 offset:64
    ds_read_b64_tr_b16 v[22:23], v240 offset:832
    ds_read_b64_tr_b16 v[24:25], v240 offset:128
    ds_read_b64_tr_b16 v[26:27], v240 offset:896
    ds_read_b64_tr_b16 v[28:29], v240 offset:3072
    ds_read_b64_tr_b16 v[30:31], v240 offset:3840
    ds_read_b64_tr_b16 v[32:33], v240 offset:3136
    ds_read_b64_tr_b16 v[34:35], v240 offset:3904
    ds_read_b64_tr_b16 v[36:37], v240 offset:3200
    ds_read_b64_tr_b16 v[38:39], v240 offset:3968
    ds_read_b64_tr_b16 v[40:41], v240 offset:6144
    ds_read_b64_tr_b16 v[42:43], v240 offset:6912
    ds_read_b64_tr_b16 v[44:45], v240 offset:6208
    ds_read_b64_tr_b16 v[46:47], v240 offset:6976
    ds_read_b64_tr_b16 v[48:49], v240 offset:6272
    ds_read_b64_tr_b16 v[50:51], v240 offset:7040
    ds_read_b64_tr_b16 v[52:53], v240 offset:9216
    ds_read_b64_tr_b16 v[54:55], v240 offset:9984
    ds_read_b64_tr_b16 v[56:57], v240 offset:9280
    ds_read_b64_tr_b16 v[58:59], v240 offset:10048
    ds_read_b64_tr_b16 v[60:61], v240 offset:9344
    ds_read_b64_tr_b16 v[62:63], v240 offset:10112
    ds_read_b64_tr_b16 v[64:65], v240 offset:12288
    ds_read_b64_tr_b16 v[66:67], v240 offset:13056
    ds_read_b64_tr_b16 v[68:69], v240 offset:12352
    ds_read_b64_tr_b16 v[70:71], v240 offset:13120
    ds_read_b64_tr_b16 v[72:73], v240 offset:12416
    ds_read_b64_tr_b16 v[74:75], v240 offset:13184
    ds_read_b64_tr_b16 v[76:77], v240 offset:15360
    ds_read_b64_tr_b16 v[78:79], v240 offset:16128
    ds_read_b64_tr_b16 v[80:81], v240 offset:15424
    ds_read_b64_tr_b16 v[82:83], v240 offset:16192
    ds_read_b64_tr_b16 v[84:85], v240 offset:15488
    ds_read_b64_tr_b16 v[86:87], v240 offset:16256
    s_waitcnt lgkmcnt(0)
    s_add_u32 s49, s49, s65
    s_add_u32 m0, s66, 0
    s_nop 0
    buffer_load_dwordx4 v245, s[52:55], s49 offen lds
    s_add_u32 m0, s66, 1024
    s_nop 0
    buffer_load_dwordx4 v246, s[52:55], s49 offen lds
    s_add_u32 m0, s66, 2048
    s_nop 0
    buffer_load_dwordx4 v247, s[52:55], s49 offen lds
    s_add_u32 s49, s49, s65
    s_add_u32 m0, s66, 3072
    s_nop 0
    buffer_load_dwordx4 v245, s[52:55], s49 offen lds
    s_add_u32 m0, s66, 4096
    s_nop 0
    buffer_load_dwordx4 v246, s[52:55], s49 offen lds
    s_add_u32 m0, s66, 5120
    s_nop 0
    buffer_load_dwordx4 v247, s[52:55], s49 offen lds
    s_add_u32 s49, s49, s65
    s_add_u32 m0, s66, 6144
    s_nop 0
    buffer_load_dwordx4 v245, s[52:55], s49 offen lds
    s_add_u32 m0, s66, 7168
    s_nop 0
    buffer_load_dwordx4 v246, s[52:55], s49 offen lds
    s_add_u32 m0, s66, 8192
    s_nop 0
    buffer_load_dwordx4 v247, s[52:55], s49 offen lds
    s_waitcnt vmcnt(0)
    ds_read_b64_tr_b16 v[88:89], v240 offset:0
    ds_read_b64_tr_b16 v[90:91], v240 offset:768
    ds_read_b64_tr_b16 v[92:93], v240 offset:64
    ds_read_b64_tr_b16 v[94:95], v240 offset:832
    ds_read_b64_tr_b16 v[96:97], v240 offset:128
    ds_read_b64_tr_b16 v[98:99], v240 offset:896
    ds_read_b64_tr_b16 v[100:101], v240 offset:3072
    ds_read_b64_tr_b16 v[102:103], v240 offset:3840
    ds_read_b64_tr_b16 v[104:105], v240 offset:3136
    ds_read_b64_tr_b16 v[106:107], v240 offset:3904
    ds_read_b64_tr_b16 v[108:109], v240 offset:3200
    ds_read_b64_tr_b16 v[110:111], v240 offset:3968
    ds_read_b64_tr_b16 v[112:113], v240 offset:6144
    ds_read_b64_tr_b16 v[114:115], v240 offset:6912
    ds_read_b64_tr_b16 v[116:117], v240 offset:6208
    ds_read_b64_tr_b16 v[118:119], v240 offset:6976
    ds_read_b64_tr_b16 v[120:121], v240 offset:6272
    ds_read_b64_tr_b16 v[122:123], v240 offset:7040
    s_waitcnt lgkmcnt(0)
    s_mov_b32 s52, s28
    s_mov_b32 s53, s29
    s_mov_b32 s54, 9437184
    s_mov_b32 s55, 0x00020000
    s_setprio 3
    s_lshl_b32 s51, s69, 13
    s_add_u32 s51, s51, 18927616
    v_lshlrev_b32 v12, 7, v1
    s_mov_b32 s68, 262144
    s_mov_b32 exec_lo, 0xffffffff
    s_mov_b32 exec_hi, 0xffffffff
L_poll_21:
    buffer_load_dword v10, v12, s[36:39], s51 offen sc1
    s_waitcnt vmcnt(0)
    v_cmp_eq_u32 vcc, s94, v10
    s_cmp_eq_u64 vcc, exec
    s_cbranch_scc1 L_polld_22
    s_sleep 4
    s_sub_u32 s68, s68, 1
    s_cmp_lg_u32 s68, 0
    s_cbranch_scc1 L_poll_21
L_polld_22:
    s_mov_b64 exec, -1
    s_mov_b64 exec, 1
    v_mov_b32 v10, 163736
    v_mov_b32 v11, 1
    ds_add_u32 v10, v11
    s_mov_b64 exec, -1
    v_mov_b32 v10, 163736
L_lw_23:
    ds_read_b32 v11, v10
    s_waitcnt lgkmcnt(0)
    v_readfirstlane_b32 s68, v11
    s_cmp_ge_u32 s68, 4
    s_cbranch_scc1 L_lwd_24
    s_sleep 2
    s_branch L_lw_23
L_lwd_24:
    s_setprio 0
    s_add_u32 m0, s56, 0
    s_add_u32 s48, s60, 0
    buffer_load_dwordx4 v228, s[40:43], s48 offen offset:0 sc1 lds
    s_add_u32 m0, s56, 0
    s_add_u32 s48, s60, 0
    buffer_load_dwordx4 v229, s[40:43], s48 offen offset:1024 sc1 lds
    s_add_u32 m0, s56, 0
    s_add_u32 s48, s60, 0
    buffer_load_dwordx4 v230, s[40:43], s48 offen offset:2048 sc1 lds
    s_add_u32 m0, s56, 0
    s_add_u32 s48, s60, 0
    buffer_load_dwordx4 v231, s[40:43], s48 offen offset:3072 sc1 lds
    s_add_u32 m0, s57, 0
    s_add_u32 s49, s61, 0
    buffer_load_dwordx4 v232, s[44:47], s49 offen offset:0 lds
    s_add_u32 m0, s57, 0
    s_add_u32 s49, s61, 0
    buffer_load_dwordx4 v233, s[44:47], s49 offen offset:1024 lds
    s_add_u32 m0, s57, 0
    s_add_u32 s49, s61, 0
    buffer_load_dwordx4 v234, s[44:47], s49 offen offset:2048 lds
    s_add_u32 m0, s57, 0
    s_add_u32 s49, s61, 0
    buffer_load_dwordx4 v235, s[44:47], s49 offen offset:3072 lds
    s_add_u32 m0, s57, 4096
    s_add_u32 s49, s61, 0
    buffer_load_dwordx4 v236, s[44:47], s49 offen offset:0 lds
    s_add_u32 m0, s57, 4096
    s_add_u32 s49, s61, 0
    buffer_load_dwordx4 v237, s[44:47], s49 offen offset:1024 lds
    s_add_u32 m0, s56, 40960
    s_add_u32 s48, s60, 262144
    buffer_load_dwordx4 v228, s[40:43], s48 offen offset:0 sc1 lds
    s_add_u32 m0, s56, 40960
    s_add_u32 s48, s60, 262144
    buffer_load_dwordx4 v229, s[40:43], s48 offen offset:1024 sc1 lds
    s_add_u32 m0, s56, 40960
    s_add_u32 s48, s60, 262144
    buffer_load_dwordx4 v230, s[40:43], s48 offen offset:2048 sc1 lds
    s_add_u32 m0, s56, 40960
    s_add_u32 s48, s60, 262144
    buffer_load_dwordx4 v231, s[40:43], s48 offen offset:3072 sc1 lds
    s_add_u32 m0, s57, 40960
    s_add_u32 s49, s61, 128
    buffer_load_dwordx4 v232, s[44:47], s49 offen offset:0 lds
    s_add_u32 m0, s57, 40960
    s_add_u32 s49, s61, 128
    buffer_load_dwordx4 v233, s[44:47], s49 offen offset:1024 lds
    s_add_u32 m0, s57, 40960
    s_add_u32 s49, s61, 128
    buffer_load_dwordx4 v234, s[44:47], s49 offen offset:2048 lds
    s_add_u32 m0, s57, 40960
    s_add_u32 s49, s61, 128
    buffer_load_dwordx4 v235, s[44:47], s49 offen offset:3072 lds
    s_add_u32 m0, s57, 45056
    s_add_u32 s49, s61, 128
    buffer_load_dwordx4 v236, s[44:47], s49 offen offset:0 lds
    s_add_u32 m0, s57, 45056
    s_add_u32 s49, s61, 128
    buffer_load_dwordx4 v237, s[44:47], s49 offen offset:1024 lds
    s_lshr_b32 s48, s35, 3
    s_lshl_b32 s48, s48, 19
    s_add_u32 s48, s48, s60
    s_add_u32 s48, s48, 786432
    buffer_load_dword v14, v254, s[36:39], s48 offen sc1
    v_and_b32 v10, 3, v1
    v_lshlrev_b32 v10, 2, v10
    v_add_u32 v10, 163808, v10
L_pw_25:
    ds_read_b32 v11, v10
    s_waitcnt lgkmcnt(0)
    v_cmp_le_u32 vcc, 122880, v11
    s_cmp_eq_u64 vcc, exec
    s_cbranch_scc1 L_pwd_26
    s_sleep 4
    s_branch L_pw_25
L_pwd_26:
    s_add_u32 m0, s56, 81920
    s_add_u32 s48, s60, 524288
    buffer_load_dwordx4 v228, s[40:43], s48 offen offset:0 sc1 lds
    s_add_u32 m0, s56, 81920
    s_add_u32 s48, s60, 524288
    buffer_load_dwordx4 v229, s[40:43], s48 offen offset:1024 sc1 lds
    s_add_u32 m0, s56, 81920
    s_add_u32 s48, s60, 524288
    buffer_load_dwordx4 v230, s[40:43], s48 offen offset:2048 sc1 lds
    s_add_u32 m0, s56, 81920
    s_add_u32 s48, s60, 524288
    buffer_load_dwordx4 v231, s[40:43], s48 offen offset:3072 sc1 lds
    s_add_u32 m0, s57, 81920
    s_add_u32 s49, s61, 256
    buffer_load_dwordx4 v232, s[44:47], s49 offen offset:0 lds
    s_add_u32 m0, s57, 81920
    s_add_u32 s49, s61, 256
    buffer_load_dwordx4 v233, s[44:47], s49 offen offset:1024 lds
    s_add_u32 m0, s57, 81920
    s_add_u32 s49, s61, 256
    buffer_load_dwordx4 v234, s[44:47], s49 offen offset:2048 lds
    s_add_u32 m0, s57, 81920
    s_add_u32 s49, s61, 256
    buffer_load_dwordx4 v235, s[44:47], s49 offen offset:3072 lds
    s_add_u32 m0, s57, 86016
    s_add_u32 s49, s61, 256
    buffer_load_dwordx4 v236, s[44:47], s49 offen offset:0 lds
    s_add_u32 m0, s57, 86016
    s_add_u32 s49, s61, 256
    buffer_load_dwordx4 v237, s[44:47], s49 offen offset:1024 lds
    v_and_b32 v10, 3, v1
    v_lshlrev_b32 v10, 2, v10
    v_add_u32 v10, 163808, v10
L_pw_27:
    ds_read_b32 v11, v10
    s_waitcnt lgkmcnt(0)
    v_cmp_le_u32 vcc, 143360, v11
    s_cmp_eq_u64 vcc, exec
    s_cbranch_scc1 L_pwd_28
    s_sleep 4
    s_branch L_pw_27
L_pwd_28:
    s_add_u32 m0, s56, 122880
    s_add_u32 s48, s60, 786432
    buffer_load_dwordx4 v228, s[40:43], s48 offen offset:0 sc1 lds
    s_add_u32 m0, s56, 122880
    s_add_u32 s48, s60, 786432
    buffer_load_dwordx4 v229, s[40:43], s48 offen offset:1024 sc1 lds
    s_add_u32 m0, s56, 122880
    s_add_u32 s48, s60, 786432
    buffer_load_dwordx4 v230, s[40:43], s48 offen offset:2048 sc1 lds
    s_add_u32 m0, s56, 122880
    s_add_u32 s48, s60, 786432
    buffer_load_dwordx4 v231, s[40:43], s48 offen offset:3072 sc1 lds
    v_and_b32 v10, 3, v1
    v_lshlrev_b32 v10, 2, v10
    v_add_u32 v10, 163808, v10
L_pw_29:
    ds_read_b32 v11, v10
    s_waitcnt lgkmcnt(0)
    v_cmp_le_u32 vcc, 163840, v11
    s_cmp_eq_u64 vcc, exec
    s_cbranch_scc1 L_pwd_30
    s_sleep 2
    s_branch L_pw_29
L_pwd_30:
    s_add_u32 m0, s57, 122880
    s_add_u32 s49, s61, 384
    buffer_load_dwordx4 v232, s[44:47], s49 offen offset:0 lds
    s_add_u32 m0, s57, 122880
    s_add_u32 s49, s61, 384
    buffer_load_dwordx4 v233, s[44:47], s49 offen offset:1024 lds
    s_add_u32 m0, s57, 122880
    s_add_u32 s49, s61, 384
    buffer_load_dwordx4 v234, s[44:47], s49 offen offset:2048 lds
    s_add_u32 m0, s57, 122880
    s_add_u32 s49, s61, 384
    buffer_load_dwordx4 v235, s[44:47], s49 offen offset:3072 lds
    s_add_u32 m0, s57, 126976
    s_add_u32 s49, s61, 384
    buffer_load_dwordx4 v236, s[44:47], s49 offen offset:0 lds
    s_waitcnt vmcnt(9)
    s_barrier
    s_add_u32 m0, s57, 126976
    s_add_u32 s49, s61, 384
    buffer_load_dwordx4 v237, s[44:47], s49 offen offset:1024 lds
    s_barrier
    s_add_u32 m0, s56, 0
    s_add_u32 s48, s60, 1048576
    buffer_load_dwordx4 v228, s[40:43], s48 offen offset:0 sc1 lds
    s_add_u32 m0, s56, 0
    s_add_u32 s48, s60, 1048576
    buffer_load_dwordx4 v229, s[40:43], s48 offen offset:1024 sc1 lds
    s_add_u32 m0, s56, 0
    s_add_u32 s48, s60, 1048576
    buffer_load_dwordx4 v230, s[40:43], s48 offen offset:2048 sc1 lds
    s_add_u32 m0, s56, 0
    s_add_u32 s48, s60, 1048576
    buffer_load_dwordx4 v231, s[40:43], s48 offen offset:3072 sc1 lds
    s_add_u32 m0, s57, 0
    s_add_u32 s49, s61, 512
    buffer_load_dwordx4 v232, s[44:47], s49 offen offset:0 lds
    s_add_u32 m0, s57, 0
    s_add_u32 s49, s61, 512
    buffer_load_dwordx4 v233, s[44:47], s49 offen offset:1024 lds
    s_add_u32 m0, s57, 0
    s_add_u32 s49, s61, 512
    buffer_load_dwordx4 v234, s[44:47], s49 offen offset:2048 lds
    s_add_u32 m0, s57, 0
    s_add_u32 s49, s61, 512
    buffer_load_dwordx4 v235, s[44:47], s49 offen offset:3072 lds
    s_add_u32 m0, s57, 4096
    s_add_u32 s49, s61, 512
    buffer_load_dwordx4 v236, s[44:47], s49 offen offset:0 lds
    s_add_u32 m0, s57, 4096
    s_add_u32 s49, s61, 512
    buffer_load_dwordx4 v237, s[44:47], s49 offen offset:1024 lds
    s_barrier
    s_add_u32 m0, s56, 40960
    s_add_u32 s48, s60, 1310720
    buffer_load_dwordx4 v228, s[40:43], s48 offen offset:0 sc1 lds
    s_add_u32 m0, s56, 40960
    s_add_u32 s48, s60, 1310720
    buffer_load_dwordx4 v229, s[40:43], s48 offen offset:1024 sc1 lds
    s_add_u32 m0, s56, 40960
    s_add_u32 s48, s60, 1310720
    buffer_load_dwordx4 v230, s[40:43], s48 offen offset:2048 sc1 lds
    s_add_u32 m0, s56, 40960
    s_add_u32 s48, s60, 1310720
    buffer_load_dwordx4 v231, s[40:43], s48 offen offset:3072 sc1 lds
    s_add_u32 m0, s57, 40960
    s_add_u32 s49, s61, 640
    buffer_load_dwordx4 v232, s[44:47], s49 offen offset:0 lds
    s_add_u32 m0, s57, 40960
    s_add_u32 s49, s61, 640
    buffer_load_dwordx4 v233, s[44:47], s49 offen offset:1024 lds
    s_add_u32 m0, s57, 40960
    s_add_u32 s49, s61, 640
    buffer_load_dwordx4 v234, s[44:47], s49 offen offset:2048 lds
    s_add_u32 m0, s57, 40960
    s_add_u32 s49, s61, 640
    buffer_load_dwordx4 v235, s[44:47], s49 offen offset:3072 lds
    s_add_u32 m0, s57, 45056
    s_add_u32 s49, s61, 640
    buffer_load_dwordx4 v236, s[44:47], s49 offen offset:0 lds
    s_add_u32 m0, s57, 45056
    s_add_u32 s49, s61, 640
    buffer_load_dwordx4 v237, s[44:47], s49 offen offset:1024 lds
    s_waitcnt vmcnt(20)
    s_barrier
    s_add_u32 m0, s56, 81920
    s_add_u32 s48, s60, 1572864
    buffer_load_dwordx4 v228, s[40:43], s48 offen offset:0 sc1 lds
    s_add_u32 m0, s56, 81920
    s_add_u32 s48, s60, 1572864
    buffer_load_dwordx4 v229, s[40:43], s48 offen offset:1024 sc1 lds
    s_add_u32 m0, s56, 81920
    s_add_u32 s48, s60, 1572864
    buffer_load_dwordx4 v230, s[40:43], s48 offen offset:2048 sc1 lds
    s_add_u32 m0, s56, 81920
    s_add_u32 s48, s60, 1572864
    buffer_load_dwordx4 v231, s[40:43], s48 offen offset:3072 sc1 lds
    s_add_u32 m0, s57, 81920
    s_add_u32 s49, s61, 768
    buffer_load_dwordx4 v232, s[44:47], s49 offen offset:0 lds
    s_add_u32 m0, s57, 81920
    s_add_u32 s49, s61, 768
    buffer_load_dwordx4 v233, s[44:47], s49 offen offset:1024 lds
    s_add_u32 m0, s57, 81920
    s_add_u32 s49, s61, 768
    buffer_load_dwordx4 v234, s[44:47], s49 offen offset:2048 lds
    s_add_u32 m0, s57, 81920
    s_add_u32 s49, s61, 768
    buffer_load_dwordx4 v235, s[44:47], s49 offen offset:3072 lds
    s_add_u32 m0, s57, 86016
    s_add_u32 s49, s61, 768
    buffer_load_dwordx4 v236, s[44:47], s49 offen offset:0 lds
    s_add_u32 m0, s57, 86016
    s_add_u32 s49, s61, 768
    buffer_load_dwordx4 v237, s[44:47], s49 offen offset:1024 lds
    s_waitcnt vmcnt(20)
    s_barrier
    s_add_u32 m0, s56, 122880
    s_add_u32 s48, s60, 1835008
    buffer_load_dwordx4 v228, s[40:43], s48 offen offset:0 sc1 lds
    s_add_u32 m0, s56, 122880
    s_add_u32 s48, s60, 1835008
    buffer_load_dwordx4 v229, s[40:43], s48 offen offset:1024 sc1 lds
    s_add_u32 m0, s56, 122880
    s_add_u32 s48, s60, 1835008
    buffer_load_dwordx4 v230, s[40:43], s48 offen offset:2048 sc1 lds
    s_add_u32 m0, s56, 122880
    s_add_u32 s48, s60, 1835008
    buffer_load_dwordx4 v231, s[40:43], s48 offen offset:3072 sc1 lds
    s_add_u32 m0, s57, 122880
    s_add_u32 s49, s61, 896
    buffer_load_dwordx4 v232, s[44:47], s49 offen offset:0 lds
    s_add_u32 m0, s57, 122880
    s_add_u32 s49, s61, 896
    buffer_load_dwordx4 v233, s[44:47], s49 offen offset:1024 lds
    s_add_u32 m0, s57, 122880
    s_add_u32 s49, s61, 896
    buffer_load_dwordx4 v234, s[44:47], s49 offen offset:2048 lds
    s_add_u32 m0, s57, 122880
    s_add_u32 s49, s61, 896
    buffer_load_dwordx4 v235, s[44:47], s49 offen offset:3072 lds
    s_add_u32 m0, s57, 126976
    s_add_u32 s49, s61, 896
    buffer_load_dwordx4 v236, s[44:47], s49 offen offset:0 lds
    s_add_u32 m0, s57, 126976
    s_add_u32 s49, s61, 896
    buffer_load_dwordx4 v237, s[44:47], s49 offen offset:1024 lds
    s_lshl_b32 s51, s58, 12
    s_add_u32 s51, s51, 18960384
    v_lshlrev_b32 v12, 7, v2
    s_waitcnt vmcnt(20)
    s_barrier
    s_add_u32 m0, s56, 0
    s_add_u32 s48, s60, 2097152
    buffer_load_dwordx4 v228, s[40:43], s48 offen offset:0 sc1 lds
    s_add_u32 m0, s56, 0
    s_add_u32 s48, s60, 2097152
    buffer_load_dwordx4 v229, s[40:43], s48 offen offset:1024 sc1 lds
    s_add_u32 m0, s56, 0
    s_add_u32 s48, s60, 2097152
    buffer_load_dwordx4 v230, s[40:43], s48 offen offset:2048 sc1 lds
    s_add_u32 m0, s56, 0
    s_add_u32 s48, s60, 2097152
    buffer_load_dwordx4 v231, s[40:43], s48 offen offset:3072 sc1 lds
    s_add_u32 m0, s57, 0
    s_add_u32 s49, s61, 1024
    buffer_load_dwordx4 v232, s[44:47], s49 offen offset:0 lds
    s_add_u32 m0, s57, 0
    s_add_u32 s49, s61, 1024
    buffer_load_dwordx4 v233, s[44:47], s49 offen offset:1024 lds
    s_add_u32 m0, s57, 0
    s_add_u32 s49, s61, 1024
    buffer_load_dwordx4 v234, s[44:47], s49 offen offset:2048 lds
    s_add_u32 m0, s57, 0
    s_add_u32 s49, s61, 1024
    buffer_load_dwordx4 v235, s[44:47], s49 offen offset:3072 lds
    s_add_u32 m0, s57, 4096
    s_add_u32 s49, s61, 1024
    buffer_load_dwordx4 v236, s[44:47], s49 offen offset:0 lds
    s_add_u32 m0, s57, 4096
    s_add_u32 s49, s61, 1024
    buffer_load_dwordx4 v237, s[44:47], s49 offen offset:1024 lds
    s_waitcnt vmcnt(20)
    s_barrier
    buffer_load_dword v10, v12, s[36:39], s51 offen sc1
    s_waitcnt vmcnt(1)
    s_barrier
    s_waitcnt vmcnt(0)
    v_cmp_eq_u32 vcc, s94, v10
    s_cmp_eq_u64 vcc, exec
    s_cbranch_scc1 L_h_oflag
    v_lshlrev_b32 v12, 7, v1
    s_mov_b32 s68, 262144
    s_mov_b32 exec_lo, 0xffffffff
    s_mov_b32 exec_hi, 0x0
L_poll_31:
    buffer_load_dword v10, v12, s[36:39], s51 offen sc1
    s_waitcnt vmcnt(0)
    v_cmp_eq_u32 vcc, s94, v10
    s_cmp_eq_u64 vcc, exec
    s_cbranch_scc1 L_polld_32
    s_sleep 1
    s_sub_u32 s68, s68, 1
    s_cmp_lg_u32 s68, 0
    s_cbranch_scc1 L_poll_31
L_polld_32:
    s_mov_b64 exec, -1
L_h_oflag:
    s_add_u32 s48, s62, 0
    buffer_load_dwordx4 v[160:163], v239, s[36:39], s48 offen sc1
    s_add_u32 s48, s62, 65536
    buffer_load_dwordx4 v[164:167], v239, s[36:39], s48 offen sc1
    s_add_u32 s48, s62, 131072
    buffer_load_dwordx4 v[168:171], v239, s[36:39], s48 offen sc1
    s_add_u32 s48, s62, 196608
    buffer_load_dwordx4 v[172:175], v239, s[36:39], s48 offen sc1
    s_add_u32 s48, s62, 262144
    buffer_load_dwordx4 v[176:179], v239, s[36:39], s48 offen sc1
    s_add_u32 s48, s62, 327680
    buffer_load_dwordx4 v[180:183], v239, s[36:39], s48 offen sc1
    s_add_u32 s48, s62, 393216
    buffer_load_dwordx4 v[184:187], v239, s[36:39], s48 offen sc1
    s_add_u32 s48, s62, 458752
    buffer_load_dwordx4 v[188:191], v239, s[36:39], s48 offen sc1
    s_add_u32 s48, s62, 524288
    buffer_load_dwordx4 v[192:195], v239, s[36:39], s48 offen sc1
    s_add_u32 s48, s62, 0
    buffer_load_dwordx4 v[124:127], v238, s[36:39], s48 offen sc1
    s_add_u32 s48, s62, 65536
    buffer_load_dwordx4 v[128:131], v238, s[36:39], s48 offen sc1
    s_add_u32 s48, s62, 131072
    buffer_load_dwordx4 v[132:135], v238, s[36:39], s48 offen sc1
    s_add_u32 s48, s62, 196608
    buffer_load_dwordx4 v[136:139], v238, s[36:39], s48 offen sc1
    s_add_u32 s48, s62, 262144
    buffer_load_dwordx4 v[140:143], v238, s[36:39], s48 offen sc1
    s_add_u32 s48, s62, 327680
    buffer_load_dwordx4 v[144:147], v238, s[36:39], s48 offen sc1
    s_add_u32 s48, s62, 393216
    buffer_load_dwordx4 v[148:151], v238, s[36:39], s48 offen sc1
    s_add_u32 s48, s62, 458752
    buffer_load_dwordx4 v[152:155], v238, s[36:39], s48 offen sc1
    s_add_u32 s48, s62, 524288
    buffer_load_dwordx4 v[156:159], v238, s[36:39], s48 offen sc1
L_h_gota:
    s_setprio 0
    s_waitcnt vmcnt(17)
    v_mfma_f32_32x32x16_bf16 v[208:223], v[160:163], v[16:19], 0
    v_mfma_f32_32x32x16_bf16 v[224:239], v[160:163], v[20:23], 0
    v_mfma_f32_32x32x16_bf16 v[240:255], v[160:163], v[24:27], 0
    s_waitcnt vmcnt(16)
    v_mfma_f32_32x32x16_bf16 v[208:223], v[164:167], v[28:31], v[208:223]
    v_mfma_f32_32x32x16_bf16 v[224:239], v[164:167], v[32:35], v[224:239]
    v_mfma_f32_32x32x16_bf16 v[240:255], v[164:167], v[36:39], v[240:255]
    s_waitcnt vmcnt(15)
    v_mfma_f32_32x32x16_bf16 v[208:223], v[168:171], v[40:43], v[208:223]
    v_mfma_f32_32x32x16_bf16 v[224:239], v[168:171], v[44:47], v[224:239]
    v_mfma_f32_32x32x16_bf16 v[240:255], v[168:171], v[48:51], v[240:255]
    s_waitcnt vmcnt(14)
    v_mfma_f32_32x32x16_bf16 v[208:223], v[172:175], v[52:55], v[208:223]
    v_mfma_f32_32x32x16_bf16 v[224:239], v[172:175], v[56:59], v[224:239]
    v_mfma_f32_32x32x16_bf16 v[240:255], v[172:175], v[60:63], v[240:255]
    s_waitcnt vmcnt(13)
    v_mfma_f32_32x32x16_bf16 v[208:223], v[176:179], v[64:67], v[208:223]
    v_mfma_f32_32x32x16_bf16 v[224:239], v[176:179], v[68:71], v[224:239]
    v_mfma_f32_32x32x16_bf16 v[240:255], v[176:179], v[72:75], v[240:255]
    s_waitcnt vmcnt(12)
    v_mfma_f32_32x32x16_bf16 v[208:223], v[180:183], v[76:79], v[208:223]
    v_mfma_f32_32x32x16_bf16 v[224:239], v[180:183], v[80:83], v[224:239]
    v_mfma_f32_32x32x16_bf16 v[240:255], v[180:183], v[84:87], v[240:255]
    s_waitcnt vmcnt(11)
    v_mfma_f32_32x32x16_bf16 v[208:223], v[184:187], v[88:91], v[208:223]
    v_mfma_f32_32x32x16_bf16 v[224:239], v[184:187], v[92:95], v[224:239]
    v_mfma_f32_32x32x16_bf16 v[240:255], v[184:187], v[96:99], v[240:255]
    s_waitcnt vmcnt(10)
    v_mfma_f32_32x32x16_bf16 v[208:223], v[188:191], v[100:103], v[208:223]
    v_mfma_f32_32x32x16_bf16 v[224:239], v[188:191], v[104:107], v[224:239]
    v_mfma_f32_32x32x16_bf16 v[240:255], v[188:191], v[108:111], v[240:255]
    s_waitcnt vmcnt(9)
    v_mfma_f32_32x32x16_bf16 v[208:223], v[192:195], v[112:115], v[208:223]
    v_mfma_f32_32x32x16_bf16 v[224:239], v[192:195], v[116:119], v[224:239]
    v_mfma_f32_32x32x16_bf16 v[240:255], v[192:195], v[120:123], v[240:255]
    s_waitcnt vmcnt(8)
    v_mfma_f32_32x32x16_bf16 v[160:175], v[124:127], v[16:19], 0
    v_mfma_f32_32x32x16_bf16 v[176:191], v[124:127], v[20:23], 0
    v_mfma_f32_32x32x16_bf16 v[192:207], v[124:127], v[24:27], 0
    s_waitcnt vmcnt(7)
    v_mfma_f32_32x32x16_bf16 v[160:175], v[128:131], v[28:31], v[160:175]
    v_mfma_f32_32x32x16_bf16 v[176:191], v[128:131], v[32:35], v[176:191]
    v_mfma_f32_32x32x16_bf16 v[192:207], v[128:131], v[36:39], v[192:207]
    s_waitcnt vmcnt(6)
    v_mfma_f32_32x32x16_bf16 v[160:175], v[132:135], v[40:43], v[160:175]
    v_mfma_f32_32x32x16_bf16 v[176:191], v[132:135], v[44:47], v[176:191]
    v_mfma_f32_32x32x16_bf16 v[192:207], v[132:135], v[48:51], v[192:207]
    s_waitcnt vmcnt(5)
    v_mfma_f32_32x32x16_bf16 v[160:175], v[136:139], v[52:55], v[160:175]
    v_mfma_f32_32x32x16_bf16 v[176:191], v[136:139], v[56:59], v[176:191]
    v_mfma_f32_32x32x16_bf16 v[192:207], v[136:139], v[60:63], v[192:207]
    v_and_b32 v10, 3, v1
    v_lshlrev_b32 v10, 2, v10
    v_add_u32 v10, 65536, v10
    s_mov_b32 s68, 0x400000
L_tw_33:
    ds_read_b32 v11, v10
    s_sub_u32 s68, s68, 1
    s_cbranch_scc1 L_tw_33x
    s_waitcnt lgkmcnt(0)
    v_cmp_eq_u32 vcc, s94, v11
    s_cmp_eq_u64 vcc, exec
    s_cbranch_scc0 L_tw_33
L_tw_33x:
    s_waitcnt lgkmcnt(0)
    s_waitcnt vmcnt(4)
    v_mfma_f32_32x32x16_bf16 v[160:175], v[140:143], v[64:67], v[160:175]
    ds_write_b128 v4, v[208:211] offset:12288
    v_mfma_f32_32x32x16_bf16 v[176:191], v[140:143], v[68:71], v[176:191]
    ds_write_b128 v4, v[212:215] offset:13312
    v_mfma_f32_32x32x16_bf16 v[192:207], v[140:143], v[72:75], v[192:207]
    ds_write_b128 v4, v[224:227] offset:14336
    s_waitcnt vmcnt(3)
    v_mfma_f32_32x32x16_bf16 v[160:175], v[144:147], v[76:79], v[160:175]
    ds_write_b128 v4, v[228:231] offset:15360
    v_mfma_f32_32x32x16_bf16 v[176:191], v[144:147], v[80:83], v[176:191]
    ds_write_b128 v4, v[240:243] offset:16384
    v_mfma_f32_32x32x16_bf16 v[192:207], v[144:147], v[84:87], v[192:207]
    ds_write_b128 v4, v[244:247] offset:17408
    s_waitcnt vmcnt(2)
    v_mfma_f32_32x32x16_bf16 v[160:175], v[148:151], v[88:91], v[160:175]
    ds_write_b128 v4, v[216:219] offset:18432
    v_mfma_f32_32x32x16_bf16 v[176:191], v[148:151], v[92:95], v[176:191]
    ds_write_b128 v4, v[220:223] offset:19456
    v_mfma_f32_32x32x16_bf16 v[192:207], v[148:151], v[96:99], v[192:207]
    ds_write_b128 v4, v[232:235] offset:20480
    s_waitcnt vmcnt(1)
    v_mfma_f32_32x32x16_bf16 v[160:175], v[152:155], v[100:103], v[160:175]
    ds_write_b128 v4, v[236:239] offset:21504
    v_mfma_f32_32x32x16_bf16 v[176:191], v[152:155], v[104:107], v[176:191]
    ds_write_b128 v4, v[248:251] offset:22528
    v_mfma_f32_32x32x16_bf16 v[192:207], v[152:155], v[108:111], v[192:207]
    ds_write_b128 v4, v[252:255] offset:23552
    s_waitcnt vmcnt(0)
    v_mfma_f32_32x32x16_bf16 v[160:175], v[156:159], v[112:115], v[160:175]
    v_mfma_f32_32x32x16_bf16 v[176:191], v[156:159], v[116:119], v[176:191]
    v_mfma_f32_32x32x16_bf16 v[192:207], v[156:159], v[120:123], v[192:207]
    s_nop 15
    s_nop 3
    ds_write_b128 v4, v[168:171] offset:6144
    ds_write_b128 v4, v[172:175] offset:7168
    ds_write_b128 v4, v[184:187] offset:8192
    ds_write_b128 v4, v[188:191] offset:9216
    ds_write_b128 v4, v[200:203] offset:10240
    ds_write_b128 v4, v[204:207] offset:11264
    s_lshl_b32 s68, s3, 2
    s_add_u32 s68, s68, 4
    v_mov_b32 v10, s68
    v_mov_b32 v11, s94
    s_waitcnt lgkmcnt(0)
    ds_write_b32 v10, v11 offset:65532
    v_and_b32 v12, 3, v1
    v_lshlrev_b32 v12, 2, v12
    v_add_u32 v12, 65552, v12
    s_mov_b32 s68, 0x400000
L_tw_34:
    ds_read_b32 v13, v12
    s_sub_u32 s68, s68, 1
    s_cbranch_scc1 L_tw_34x
    s_waitcnt lgkmcnt(0)
    v_cmp_eq_u32 vcc, s94, v13
    s_cmp_eq_u64 vcc, exec
    s_cbranch_scc0 L_tw_34
L_tw_34x:
    s_waitcnt lgkmcnt(0)
    ds_read_b128 v[16:19], v5 offset:0
    ds_read_b128 v[20:23], v5 offset:1024
    ds_read_b128 v[24:27], v5 offset:2048
    ds_read_b128 v[28:31], v5 offset:3072
    ds_read_b128 v[32:35], v5 offset:4096
    ds_read_b128 v[36:39], v5 offset:5120
    ds_read_b128 v[40:43], v6 offset:0
    ds_read_b128 v[44:47], v6 offset:1024
    ds_read_b128 v[48:51], v6 offset:2048
    ds_read_b128 v[52:55], v6 offset:3072
    ds_read_b128 v[56:59], v6 offset:4096
    ds_read_b128 v[60:63], v6 offset:5120
    ds_read_b128 v[64:67], v7 offset:0
    ds_read_b128 v[68:71], v7 offset:1024
    ds_read_b128 v[72:75], v7 offset:2048
    ds_read_b128 v[76:79], v7 offset:3072
    ds_read_b128 v[80:83], v7 offset:4096
    ds_read_b128 v[84:87], v7 offset:5120
    s_waitcnt lgkmcnt(12)
    v_pk_add_f32 v[160:161], v[160:161], v[16:17]
    v_pk_add_f32 v[162:163], v[162:163], v[18:19]
    v_pk_add_f32 v[164:165], v[164:165], v[20:21]
    v_pk_add_f32 v[166:167], v[166:167], v[22:23]
    v_pk_add_f32 v[176:177], v[176:177], v[24:25]
    v_pk_add_f32 v[178:179], v[178:179], v[26:27]
    v_pk_add_f32 v[180:181], v[180:181], v[28:29]
    v_pk_add_f32 v[182:183], v[182:183], v[30:31]
    v_pk_add_f32 v[192:193], v[192:193], v[32:33]
    v_pk_add_f32 v[194:195], v[194:195], v[34:35]
    v_pk_add_f32 v[196:197], v[196:197], v[36:37]
    v_pk_add_f32 v[198:199], v[198:199], v[38:39]
    s_waitcnt lgkmcnt(6)
    v_pk_add_f32 v[160:161], v[160:161], v[40:41]
    v_pk_add_f32 v[162:163], v[162:163], v[42:43]
    v_pk_add_f32 v[164:165], v[164:165], v[44:45]
    v_pk_add_f32 v[166:167], v[166:167], v[46:47]
    v_pk_add_f32 v[176:177], v[176:177], v[48:49]
    v_pk_add_f32 v[178:179], v[178:179], v[50:51]
    v_pk_add_f32 v[180:181], v[180:181], v[52:53]
    v_pk_add_f32 v[182:183], v[182:183], v[54:55]
    v_pk_add_f32 v[192:193], v[192:193], v[56:57]
    v_pk_add_f32 v[194:195], v[194:195], v[58:59]
    v_pk_add_f32 v[196:197], v[196:197], v[60:61]
    v_pk_add_f32 v[198:199], v[198:199], v[62:63]
    s_waitcnt lgkmcnt(0)
    v_pk_add_f32 v[160:161], v[160:161], v[64:65]
    v_pk_add_f32 v[162:163], v[162:163], v[66:67]
    v_pk_add_f32 v[164:165], v[164:165], v[68:69]
    v_pk_add_f32 v[166:167], v[166:167], v[70:71]
    v_pk_add_f32 v[176:177], v[176:177], v[72:73]
    v_pk_add_f32 v[178:179], v[178:179], v[74:75]
    v_pk_add_f32 v[180:181], v[180:181], v[76:77]
    v_pk_add_f32 v[182:183], v[182:183], v[78:79]
    v_pk_add_f32 v[192:193], v[192:193], v[80:81]
    v_pk_add_f32 v[194:195], v[194:195], v[82:83]
    v_pk_add_f32 v[196:197], v[196:197], v[84:85]
    v_pk_add_f32 v[198:199], v[198:199], v[86:87]
    s_add_u32 s63, s50, 0
    buffer_store_dword v160, v8, s[52:55], s63 offen offset:0 sc1
    buffer_store_dword v176, v8, s[52:55], s63 offen offset:128 sc1
    buffer_store_dword v192, v8, s[52:55], s63 offen offset:256 sc1
    s_add_u32 s63, s50, 4608
    buffer_store_dword v161, v8, s[52:55], s63 offen offset:0 sc1
    buffer_store_dword v177, v8, s[52:55], s63 offen offset:128 sc1
    buffer_store_dword v193, v8, s[52:55], s63 offen offset:256 sc1
    s_add_u32 s63, s50, 9216
    buffer_store_dword v162, v8, s[52:55], s63 offen offset:0 sc1
    buffer_store_dword v178, v8, s[52:55], s63 offen offset:128 sc1
    buffer_store_dword v194, v8, s[52:55], s63 offen offset:256 sc1
    s_add_u32 s63, s50, 13824
    buffer_store_dword v163, v8, s[52:55], s63 offen offset:0 sc1
    buffer_store_dword v179, v8, s[52:55], s63 offen offset:128 sc1
    buffer_store_dword v195, v8, s[52:55], s63 offen offset:256 sc1
    s_add_u32 s63, s50, 36864
    buffer_store_dword v164, v8, s[52:55], s63 offen offset:0 sc1
    buffer_store_dword v180, v8, s[52:55], s63 offen offset:128 sc1
    buffer_store_dword v196, v8, s[52:55], s63 offen offset:256 sc1
    s_add_u32 s63, s50, 41472
    buffer_store_dword v165, v8, s[52:55], s63 offen offset:0 sc1
    buffer_store_dword v181, v8, s[52:55], s63 offen offset:128 sc1
    buffer_store_dword v197, v8, s[52:55], s63 offen offset:256 sc1
    s_add_u32 s63, s50, 46080
    buffer_store_dword v166, v8, s[52:55], s63 offen offset:0 sc1
    buffer_store_dword v182, v8, s[52:55], s63 offen offset:128 sc1
    buffer_store_dword v198, v8, s[52:55], s63 offen offset:256 sc1
    s_add_u32 s63, s50, 50688
    buffer_store_dword v167, v8, s[52:55], s63 offen offset:0 sc1
    buffer_store_dword v183, v8, s[52:55], s63 offen offset:128 sc1
    buffer_store_dword v199, v8, s[52:55], s63 offen offset:256 sc1
L_h_nop3:
    s_endpgm
L_exit:
    s_endpgm
.section .rodata,"a"
.p2align 6
.amdhsa_kernel concat_heads__softmax_full_mha__ssm_conv_s5__prompt_kernel
  .amdhsa_next_free_vgpr 256
  .amdhsa_next_free_sgpr 102
  .amdhsa_accum_offset 256
  .amdhsa_group_segment_fixed_size 0
  .amdhsa_kernarg_size 120
  .amdhsa_user_sgpr_count 2
  .amdhsa_user_sgpr_kernarg_segment_ptr 1
  .amdhsa_system_sgpr_workgroup_id_x 1
.end_amdhsa_kernel
```
